```python
import torch

def _softmax(x, axis=-1):
    return torch.softmax(x, dim=axis)
def _gelu(x):
    return torch.nn.functional.gelu(x, approximate="tanh")
def _silu(x):
    return torch.nn.functional.silu(x)
def _sigmoid(x):
    return torch.sigmoid(x)
def _layernorm(x, axis=-1, eps=1e-5):
    m = x.mean(dim=axis, keepdim=True)
    v = x.var(dim=axis, keepdim=True, unbiased=False)
    return (x - m) / torch.sqrt(v + eps)
def _scatter_add(tgt, idx, src, axis=0):
    return tgt.clone().index_add_(axis, idx, src)
def _segment_sum(src, seg, n):
    out = torch.zeros((n,) + src.shape[1:], dtype=src.dtype)
    return out.index_add_(0, seg, src)
def _pad(x, pw):
    flat = tuple(v for pair in reversed(pw) for v in pair)
    return torch.nn.functional.pad(x, flat)

kernel_name = 'sequential_preLN__linear_attn_block__glu_gated_bilinear__prompt'

def setup_inputs():

    _w = (lambda a: (lambda t: t.to(torch.bfloat16) if t.is_floating_point() else t)(torch.as_tensor(a)))
    def _A_setup():
        B, S, D = 1, 2048, 512
        return {
            "x": _w((lambda *s: torch.randn(*s, dtype=torch.bfloat16) * 0.05)(B, S, D)),
            "wqkv": _w((lambda *s: torch.randn(*s, dtype=torch.bfloat16) * 0.05)(D, 3 * D)),
            "wo": _w((lambda *s: torch.randn(*s, dtype=torch.bfloat16) * 0.05)(D, D)),
        }
    _A_in = _A_setup()

    def _B_setup():
        B, S, D, F = 1, 2048, 512, 1376
        return {
            "x": _w((lambda *s: torch.randn(*s, dtype=torch.bfloat16) * 0.05)(B, S, D)),
            "w_gate": _w((lambda *s: torch.randn(*s, dtype=torch.bfloat16) * 0.2)(D, F) * (D ** -0.5)),
            "w_up": _w((lambda *s: torch.randn(*s, dtype=torch.bfloat16) * 0.2)(D, F) * (D ** -0.5)),
            "w_down": _w((lambda *s: torch.randn(*s, dtype=torch.bfloat16) * 0.2)(F, D) * (F ** -0.5)),
        }
    _B_in = _B_setup()

    return {
        "A_x": _A_in["x"],
        "A_wqkv": _A_in["wqkv"],
        "A_wo": _A_in["wo"],
        "B_x": _B_in["x"],
        "B_w_gate": _B_in["w_gate"],
        "B_w_up": _B_in["w_up"],
        "B_w_down": _B_in["w_down"],
    }

def reference(A_x, A_wqkv, A_wo, B_x, B_w_gate, B_w_up, B_w_down):
    def _A_ref(x, wqkv, wo):
        B, S, D = x.shape
        H = 32; Dh = D // H
        qkv = (lambda x, *d: x.permute(*d))((x @ wqkv).reshape(B, S, 3, H, Dh), 2, 0, 3, 1, 4)
        q, k, v = qkv[0], qkv[1], qkv[2]
        phi = lambda t: torch.where(t > 0, t + 1, torch.exp(t)) + 1e-6
        pq, pk = phi(q), phi(k)
        kv = torch.einsum("bhsd,bhse->bhde", pk, v)
        z = torch.einsum("bhsd->bhd", pk)
        num = torch.einsum("bhqd,bhde->bhqe", pq, kv)
        den = torch.einsum("bhqd,bhd->bhq", pq, z)[..., None] + 1e-6
        o = num / den
        return (lambda x, *d: x.permute(*d))(o, 0, 2, 1, 3).reshape(B, S, D) @ wo

    def _B_ref(x, w_gate, w_up, w_down):
        g = torch.einsum("bsd,df->bsf", x, w_gate)
        u = torch.einsum("bsd,df->bsf", x, w_up)
        h = g * u
        return torch.einsum("bsf,fd->bsd", h, w_down)

    x = A_x
    h = x + _A_ref(_layernorm(x, axis=-1), A_wqkv, A_wo)
    h2 = h + _B_ref(_layernorm(h, axis=-1), B_w_gate, B_w_up, B_w_down)
    return h2
```

```asm
; @launch kernel=k1_kernel grid=(256,1,1) block=(320,1,1) lds=143360
; @launch kernel=k2_kernel grid=(256,1,1) block=(320,1,1) lds=151808
; @launch kernel=k3_kernel grid=(240,1,1) block=(320,1,1) lds=163840
; @launch kernel=k4_kernel grid=(256,1,1) block=(320,1,1) lds=131072
.amdgcn_target "amdgcn-amd-amdhsa--gfx950"
.text
.globl k1_kernel
.p2align 8
.type k1_kernel,@function
k1_kernel:
    s_cmp_ge_u32 s2, 256
    s_cbranch_scc1 k1_end
    s_load_dwordx4 s[4:7], s[0:1], 0
    s_load_dwordx4 s[24:27], s[0:1], 64
    s_and_b32 s28, s2, 7
    s_lshr_b32 s29, s2, 3
    s_lshr_b32 s30, s28, 1
    s_lshl_b32 s30, s30, 2
    s_and_b32 s31, s29, 3
    s_add_u32 s30, s30, s31
    s_and_b32 s31, s28, 1
    s_lshl_b32 s31, s31, 3
    s_lshr_b32 s29, s29, 2
    s_add_u32 s31, s31, s29
    v_and_b32 v1, 63, v0
    v_lshrrev_b32 v8, 6, v0
    v_and_b32 v2, 31, v1
    v_lshrrev_b32 v3, 5, v1
    v_readfirstlane_b32 s32, v8
    s_waitcnt lgkmcnt(0)
    s_mov_b32 s8, s4
    s_and_b32 s9, s5, 0xffff
    s_mov_b32 s10, 2097152
    s_mov_b32 s11, 0x00020000
    s_mov_b32 s12, s6
    s_and_b32 s13, s7, 0xffff
    s_mov_b32 s14, 1572864
    s_mov_b32 s15, 0x00020000
    s_mov_b32 s16, s26
    s_and_b32 s17, s27, 0xffff
    s_mov_b32 s18, 16777216
    s_mov_b32 s19, 0x00020000
    s_mov_b32 s20, s24
    s_and_b32 s21, s25, 0xffff
    s_mov_b32 s22, 256
    s_mov_b32 s23, 0x00020000
    s_lshl_b32 s33, s30, 7
    s_lshl_b32 s34, s32, 5
    s_add_u32 s47, s33, s34
    s_cmp_lg_u32 s32, 4
    s_cbranch_scc1 k1_compute
    v_lshrrev_b32 v8, 3, v1
    v_mul_u32_u24 v4, 1024, v8
    v_lshrrev_b32 v8, 4, v1
    v_and_b32 v9, 7, v1
    v_xor_b32 v9, v9, v8
    v_lshl_add_u32 v4, v9, 4, v4
    v_xor_b32 v5, 64, v4
    v_lshrrev_b32 v8, 2, v1
    v_mul_u32_u24 v6, 3072, v8
    v_and_b32 v8, 3, v1
    v_lshl_add_u32 v6, v8, 4, v6
    s_lshl_b32 s48, s33, 10
    s_lshl_b32 s35, s31, 6
    s_mov_b32 m0, 0
    s_add_u32 s36, s48, 0
    buffer_load_dwordx4 v4, s[8:11], s36 offen lds
    s_mov_b32 m0, 1024
    s_add_u32 s36, s48, 8192
    buffer_load_dwordx4 v5, s[8:11], s36 offen lds
    s_mov_b32 m0, 2048
    s_add_u32 s36, s48, 16384
    buffer_load_dwordx4 v4, s[8:11], s36 offen lds
    s_mov_b32 m0, 3072
    s_add_u32 s36, s48, 24576
    buffer_load_dwordx4 v5, s[8:11], s36 offen lds
    s_mov_b32 m0, 16384
    s_add_u32 s36, s35, 0
    buffer_load_dwordx4 v6, s[12:15], s36 offen lds
    s_mov_b32 m0, 20480
    s_add_u32 s36, s35, 1024
    buffer_load_dwordx4 v6, s[12:15], s36 offen lds
    s_mov_b32 m0, 24576
    s_add_u32 s36, s35, 2048
    buffer_load_dwordx4 v6, s[12:15], s36 offen lds
    s_mov_b32 m0, 4096
    s_add_u32 s36, s48, 32768
    buffer_load_dwordx4 v4, s[8:11], s36 offen lds
    s_mov_b32 m0, 5120
    s_add_u32 s36, s48, 40960
    buffer_load_dwordx4 v5, s[8:11], s36 offen lds
    s_mov_b32 m0, 6144
    s_add_u32 s36, s48, 49152
    buffer_load_dwordx4 v4, s[8:11], s36 offen lds
    s_mov_b32 m0, 7168
    s_add_u32 s36, s48, 57344
    buffer_load_dwordx4 v5, s[8:11], s36 offen lds
    s_mov_b32 m0, 17408
    s_add_u32 s36, s35, 49152
    buffer_load_dwordx4 v6, s[12:15], s36 offen lds
    s_mov_b32 m0, 21504
    s_add_u32 s36, s35, 50176
    buffer_load_dwordx4 v6, s[12:15], s36 offen lds
    s_mov_b32 m0, 25600
    s_add_u32 s36, s35, 51200
    buffer_load_dwordx4 v6, s[12:15], s36 offen lds
    s_mov_b32 m0, 8192
    s_add_u32 s36, s48, 65536
    buffer_load_dwordx4 v4, s[8:11], s36 offen lds
    s_mov_b32 m0, 9216
    s_add_u32 s36, s48, 73728
    buffer_load_dwordx4 v5, s[8:11], s36 offen lds
    s_mov_b32 m0, 10240
    s_add_u32 s36, s48, 81920
    buffer_load_dwordx4 v4, s[8:11], s36 offen lds
    s_mov_b32 m0, 11264
    s_add_u32 s36, s48, 90112
    buffer_load_dwordx4 v5, s[8:11], s36 offen lds
    s_mov_b32 m0, 18432
    s_add_u32 s36, s35, 98304
    buffer_load_dwordx4 v6, s[12:15], s36 offen lds
    s_mov_b32 m0, 22528
    s_add_u32 s36, s35, 99328
    buffer_load_dwordx4 v6, s[12:15], s36 offen lds
    s_mov_b32 m0, 26624
    s_add_u32 s36, s35, 100352
    buffer_load_dwordx4 v6, s[12:15], s36 offen lds
    s_mov_b32 m0, 12288
    s_add_u32 s36, s48, 98304
    buffer_load_dwordx4 v4, s[8:11], s36 offen lds
    s_mov_b32 m0, 13312
    s_add_u32 s36, s48, 106496
    buffer_load_dwordx4 v5, s[8:11], s36 offen lds
    s_mov_b32 m0, 14336
    s_add_u32 s36, s48, 114688
    buffer_load_dwordx4 v4, s[8:11], s36 offen lds
    s_mov_b32 m0, 15360
    s_add_u32 s36, s48, 122880
    buffer_load_dwordx4 v5, s[8:11], s36 offen lds
    s_mov_b32 m0, 19456
    s_add_u32 s36, s35, 147456
    buffer_load_dwordx4 v6, s[12:15], s36 offen lds
    s_mov_b32 m0, 23552
    s_add_u32 s36, s35, 148480
    buffer_load_dwordx4 v6, s[12:15], s36 offen lds
    s_mov_b32 m0, 27648
    s_add_u32 s36, s35, 149504
    buffer_load_dwordx4 v6, s[12:15], s36 offen lds
    s_mov_b32 m0, 28672
    s_add_u32 s36, s48, 128
    buffer_load_dwordx4 v4, s[8:11], s36 offen lds
    s_mov_b32 m0, 29696
    s_add_u32 s36, s48, 8320
    buffer_load_dwordx4 v5, s[8:11], s36 offen lds
    s_mov_b32 m0, 30720
    s_add_u32 s36, s48, 16512
    buffer_load_dwordx4 v4, s[8:11], s36 offen lds
    s_mov_b32 m0, 31744
    s_add_u32 s36, s48, 24704
    buffer_load_dwordx4 v5, s[8:11], s36 offen lds
    s_mov_b32 m0, 45056
    s_add_u32 s36, s35, 196608
    buffer_load_dwordx4 v6, s[12:15], s36 offen lds
    s_mov_b32 m0, 49152
    s_add_u32 s36, s35, 197632
    buffer_load_dwordx4 v6, s[12:15], s36 offen lds
    s_mov_b32 m0, 53248
    s_add_u32 s36, s35, 198656
    buffer_load_dwordx4 v6, s[12:15], s36 offen lds
    s_mov_b32 m0, 32768
    s_add_u32 s36, s48, 32896
    buffer_load_dwordx4 v4, s[8:11], s36 offen lds
    s_mov_b32 m0, 33792
    s_add_u32 s36, s48, 41088
    buffer_load_dwordx4 v5, s[8:11], s36 offen lds
    s_mov_b32 m0, 34816
    s_add_u32 s36, s48, 49280
    buffer_load_dwordx4 v4, s[8:11], s36 offen lds
    s_mov_b32 m0, 35840
    s_add_u32 s36, s48, 57472
    buffer_load_dwordx4 v5, s[8:11], s36 offen lds
    s_mov_b32 m0, 46080
    s_add_u32 s36, s35, 245760
    buffer_load_dwordx4 v6, s[12:15], s36 offen lds
    s_mov_b32 m0, 50176
    s_add_u32 s36, s35, 246784
    buffer_load_dwordx4 v6, s[12:15], s36 offen lds
    s_mov_b32 m0, 54272
    s_add_u32 s36, s35, 247808
    buffer_load_dwordx4 v6, s[12:15], s36 offen lds
    s_mov_b32 m0, 36864
    s_add_u32 s36, s48, 65664
    buffer_load_dwordx4 v4, s[8:11], s36 offen lds
    s_mov_b32 m0, 37888
    s_add_u32 s36, s48, 73856
    buffer_load_dwordx4 v5, s[8:11], s36 offen lds
    s_mov_b32 m0, 38912
    s_add_u32 s36, s48, 82048
    buffer_load_dwordx4 v4, s[8:11], s36 offen lds
    s_mov_b32 m0, 39936
    s_add_u32 s36, s48, 90240
    buffer_load_dwordx4 v5, s[8:11], s36 offen lds
    s_mov_b32 m0, 47104
    s_add_u32 s36, s35, 294912
    buffer_load_dwordx4 v6, s[12:15], s36 offen lds
    s_mov_b32 m0, 51200
    s_add_u32 s36, s35, 295936
    buffer_load_dwordx4 v6, s[12:15], s36 offen lds
    s_mov_b32 m0, 55296
    s_add_u32 s36, s35, 296960
    buffer_load_dwordx4 v6, s[12:15], s36 offen lds
    s_mov_b32 m0, 40960
    s_add_u32 s36, s48, 98432
    buffer_load_dwordx4 v4, s[8:11], s36 offen lds
    s_mov_b32 m0, 41984
    s_add_u32 s36, s48, 106624
    buffer_load_dwordx4 v5, s[8:11], s36 offen lds
    s_mov_b32 m0, 43008
    s_add_u32 s36, s48, 114816
    buffer_load_dwordx4 v4, s[8:11], s36 offen lds
    s_mov_b32 m0, 44032
    s_add_u32 s36, s48, 123008
    buffer_load_dwordx4 v5, s[8:11], s36 offen lds
    s_mov_b32 m0, 48128
    s_add_u32 s36, s35, 344064
    buffer_load_dwordx4 v6, s[12:15], s36 offen lds
    s_mov_b32 m0, 52224
    s_add_u32 s36, s35, 345088
    buffer_load_dwordx4 v6, s[12:15], s36 offen lds
    s_mov_b32 m0, 56320
    s_add_u32 s36, s35, 346112
    buffer_load_dwordx4 v6, s[12:15], s36 offen lds
    s_waitcnt vmcnt(28)
    s_barrier
    s_mov_b32 m0, 57344
    s_add_u32 s36, s48, 256
    buffer_load_dwordx4 v4, s[8:11], s36 offen lds
    s_mov_b32 m0, 58368
    s_add_u32 s36, s48, 8448
    buffer_load_dwordx4 v5, s[8:11], s36 offen lds
    s_mov_b32 m0, 59392
    s_add_u32 s36, s48, 16640
    buffer_load_dwordx4 v4, s[8:11], s36 offen lds
    s_mov_b32 m0, 60416
    s_add_u32 s36, s48, 24832
    buffer_load_dwordx4 v5, s[8:11], s36 offen lds
    s_mov_b32 m0, 73728
    s_add_u32 s36, s35, 393216
    buffer_load_dwordx4 v6, s[12:15], s36 offen lds
    s_mov_b32 m0, 77824
    s_add_u32 s36, s35, 394240
    buffer_load_dwordx4 v6, s[12:15], s36 offen lds
    s_mov_b32 m0, 81920
    s_add_u32 s36, s35, 395264
    buffer_load_dwordx4 v6, s[12:15], s36 offen lds
    s_mov_b32 m0, 61440
    s_add_u32 s36, s48, 33024
    buffer_load_dwordx4 v4, s[8:11], s36 offen lds
    s_mov_b32 m0, 62464
    s_add_u32 s36, s48, 41216
    buffer_load_dwordx4 v5, s[8:11], s36 offen lds
    s_mov_b32 m0, 63488
    s_add_u32 s36, s48, 49408
    buffer_load_dwordx4 v4, s[8:11], s36 offen lds
    s_mov_b32 m0, 64512
    s_add_u32 s36, s48, 57600
    buffer_load_dwordx4 v5, s[8:11], s36 offen lds
    s_mov_b32 m0, 74752
    s_add_u32 s36, s35, 442368
    buffer_load_dwordx4 v6, s[12:15], s36 offen lds
    s_mov_b32 m0, 78848
    s_add_u32 s36, s35, 443392
    buffer_load_dwordx4 v6, s[12:15], s36 offen lds
    s_mov_b32 m0, 82944
    s_add_u32 s36, s35, 444416
    buffer_load_dwordx4 v6, s[12:15], s36 offen lds
    s_mov_b32 m0, 65536
    s_add_u32 s36, s48, 65792
    buffer_load_dwordx4 v4, s[8:11], s36 offen lds
    s_mov_b32 m0, 66560
    s_add_u32 s36, s48, 73984
    buffer_load_dwordx4 v5, s[8:11], s36 offen lds
    s_mov_b32 m0, 67584
    s_add_u32 s36, s48, 82176
    buffer_load_dwordx4 v4, s[8:11], s36 offen lds
    s_mov_b32 m0, 68608
    s_add_u32 s36, s48, 90368
    buffer_load_dwordx4 v5, s[8:11], s36 offen lds
    s_mov_b32 m0, 75776
    s_add_u32 s36, s35, 491520
    buffer_load_dwordx4 v6, s[12:15], s36 offen lds
    s_mov_b32 m0, 79872
    s_add_u32 s36, s35, 492544
    buffer_load_dwordx4 v6, s[12:15], s36 offen lds
    s_mov_b32 m0, 83968
    s_add_u32 s36, s35, 493568
    buffer_load_dwordx4 v6, s[12:15], s36 offen lds
    s_mov_b32 m0, 69632
    s_add_u32 s36, s48, 98560
    buffer_load_dwordx4 v4, s[8:11], s36 offen lds
    s_mov_b32 m0, 70656
    s_add_u32 s36, s48, 106752
    buffer_load_dwordx4 v5, s[8:11], s36 offen lds
    s_mov_b32 m0, 71680
    s_add_u32 s36, s48, 114944
    buffer_load_dwordx4 v4, s[8:11], s36 offen lds
    s_mov_b32 m0, 72704
    s_add_u32 s36, s48, 123136
    buffer_load_dwordx4 v5, s[8:11], s36 offen lds
    s_mov_b32 m0, 76800
    s_add_u32 s36, s35, 540672
    buffer_load_dwordx4 v6, s[12:15], s36 offen lds
    s_mov_b32 m0, 80896
    s_add_u32 s36, s35, 541696
    buffer_load_dwordx4 v6, s[12:15], s36 offen lds
    s_mov_b32 m0, 84992
    s_add_u32 s36, s35, 542720
    buffer_load_dwordx4 v6, s[12:15], s36 offen lds
    s_waitcnt vmcnt(28)
    s_barrier
    s_mov_b32 m0, 86016
    s_add_u32 s36, s48, 384
    buffer_load_dwordx4 v4, s[8:11], s36 offen lds
    s_mov_b32 m0, 87040
    s_add_u32 s36, s48, 8576
    buffer_load_dwordx4 v5, s[8:11], s36 offen lds
    s_mov_b32 m0, 88064
    s_add_u32 s36, s48, 16768
    buffer_load_dwordx4 v4, s[8:11], s36 offen lds
    s_mov_b32 m0, 89088
    s_add_u32 s36, s48, 24960
    buffer_load_dwordx4 v5, s[8:11], s36 offen lds
    s_mov_b32 m0, 102400
    s_add_u32 s36, s35, 589824
    buffer_load_dwordx4 v6, s[12:15], s36 offen lds
    s_mov_b32 m0, 106496
    s_add_u32 s36, s35, 590848
    buffer_load_dwordx4 v6, s[12:15], s36 offen lds
    s_mov_b32 m0, 110592
    s_add_u32 s36, s35, 591872
    buffer_load_dwordx4 v6, s[12:15], s36 offen lds
    s_mov_b32 m0, 90112
    s_add_u32 s36, s48, 33152
    buffer_load_dwordx4 v4, s[8:11], s36 offen lds
    s_mov_b32 m0, 91136
    s_add_u32 s36, s48, 41344
    buffer_load_dwordx4 v5, s[8:11], s36 offen lds
    s_mov_b32 m0, 92160
    s_add_u32 s36, s48, 49536
    buffer_load_dwordx4 v4, s[8:11], s36 offen lds
    s_mov_b32 m0, 93184
    s_add_u32 s36, s48, 57728
    buffer_load_dwordx4 v5, s[8:11], s36 offen lds
    s_mov_b32 m0, 103424
    s_add_u32 s36, s35, 638976
    buffer_load_dwordx4 v6, s[12:15], s36 offen lds
    s_mov_b32 m0, 107520
    s_add_u32 s36, s35, 640000
    buffer_load_dwordx4 v6, s[12:15], s36 offen lds
    s_mov_b32 m0, 111616
    s_add_u32 s36, s35, 641024
    buffer_load_dwordx4 v6, s[12:15], s36 offen lds
    s_mov_b32 m0, 94208
    s_add_u32 s36, s48, 65920
    buffer_load_dwordx4 v4, s[8:11], s36 offen lds
    s_mov_b32 m0, 95232
    s_add_u32 s36, s48, 74112
    buffer_load_dwordx4 v5, s[8:11], s36 offen lds
    s_mov_b32 m0, 96256
    s_add_u32 s36, s48, 82304
    buffer_load_dwordx4 v4, s[8:11], s36 offen lds
    s_mov_b32 m0, 97280
    s_add_u32 s36, s48, 90496
    buffer_load_dwordx4 v5, s[8:11], s36 offen lds
    s_mov_b32 m0, 104448
    s_add_u32 s36, s35, 688128
    buffer_load_dwordx4 v6, s[12:15], s36 offen lds
    s_mov_b32 m0, 108544
    s_add_u32 s36, s35, 689152
    buffer_load_dwordx4 v6, s[12:15], s36 offen lds
    s_mov_b32 m0, 112640
    s_add_u32 s36, s35, 690176
    buffer_load_dwordx4 v6, s[12:15], s36 offen lds
    s_mov_b32 m0, 98304
    s_add_u32 s36, s48, 98688
    buffer_load_dwordx4 v4, s[8:11], s36 offen lds
    s_mov_b32 m0, 99328
    s_add_u32 s36, s48, 106880
    buffer_load_dwordx4 v5, s[8:11], s36 offen lds
    s_mov_b32 m0, 100352
    s_add_u32 s36, s48, 115072
    buffer_load_dwordx4 v4, s[8:11], s36 offen lds
    s_mov_b32 m0, 101376
    s_add_u32 s36, s48, 123264
    buffer_load_dwordx4 v5, s[8:11], s36 offen lds
    s_mov_b32 m0, 105472
    s_add_u32 s36, s35, 737280
    buffer_load_dwordx4 v6, s[12:15], s36 offen lds
    s_mov_b32 m0, 109568
    s_add_u32 s36, s35, 738304
    buffer_load_dwordx4 v6, s[12:15], s36 offen lds
    s_mov_b32 m0, 113664
    s_add_u32 s36, s35, 739328
    buffer_load_dwordx4 v6, s[12:15], s36 offen lds
    s_waitcnt vmcnt(28)
    s_barrier
    s_mov_b32 m0, 114688
    s_add_u32 s36, s48, 512
    buffer_load_dwordx4 v4, s[8:11], s36 offen lds
    s_mov_b32 m0, 115712
    s_add_u32 s36, s48, 8704
    buffer_load_dwordx4 v5, s[8:11], s36 offen lds
    s_mov_b32 m0, 116736
    s_add_u32 s36, s48, 16896
    buffer_load_dwordx4 v4, s[8:11], s36 offen lds
    s_mov_b32 m0, 117760
    s_add_u32 s36, s48, 25088
    buffer_load_dwordx4 v5, s[8:11], s36 offen lds
    s_mov_b32 m0, 131072
    s_add_u32 s36, s35, 786432
    buffer_load_dwordx4 v6, s[12:15], s36 offen lds
    s_mov_b32 m0, 135168
    s_add_u32 s36, s35, 787456
    buffer_load_dwordx4 v6, s[12:15], s36 offen lds
    s_mov_b32 m0, 139264
    s_add_u32 s36, s35, 788480
    buffer_load_dwordx4 v6, s[12:15], s36 offen lds
    s_mov_b32 m0, 118784
    s_add_u32 s36, s48, 33280
    buffer_load_dwordx4 v4, s[8:11], s36 offen lds
    s_mov_b32 m0, 119808
    s_add_u32 s36, s48, 41472
    buffer_load_dwordx4 v5, s[8:11], s36 offen lds
    s_mov_b32 m0, 120832
    s_add_u32 s36, s48, 49664
    buffer_load_dwordx4 v4, s[8:11], s36 offen lds
    s_mov_b32 m0, 121856
    s_add_u32 s36, s48, 57856
    buffer_load_dwordx4 v5, s[8:11], s36 offen lds
    s_mov_b32 m0, 132096
    s_add_u32 s36, s35, 835584
    buffer_load_dwordx4 v6, s[12:15], s36 offen lds
    s_mov_b32 m0, 136192
    s_add_u32 s36, s35, 836608
    buffer_load_dwordx4 v6, s[12:15], s36 offen lds
    s_mov_b32 m0, 140288
    s_add_u32 s36, s35, 837632
    buffer_load_dwordx4 v6, s[12:15], s36 offen lds
    s_mov_b32 m0, 122880
    s_add_u32 s36, s48, 66048
    buffer_load_dwordx4 v4, s[8:11], s36 offen lds
    s_mov_b32 m0, 123904
    s_add_u32 s36, s48, 74240
    buffer_load_dwordx4 v5, s[8:11], s36 offen lds
    s_mov_b32 m0, 124928
    s_add_u32 s36, s48, 82432
    buffer_load_dwordx4 v4, s[8:11], s36 offen lds
    s_mov_b32 m0, 125952
    s_add_u32 s36, s48, 90624
    buffer_load_dwordx4 v5, s[8:11], s36 offen lds
    s_mov_b32 m0, 133120
    s_add_u32 s36, s35, 884736
    buffer_load_dwordx4 v6, s[12:15], s36 offen lds
    s_mov_b32 m0, 137216
    s_add_u32 s36, s35, 885760
    buffer_load_dwordx4 v6, s[12:15], s36 offen lds
    s_mov_b32 m0, 141312
    s_add_u32 s36, s35, 886784
    buffer_load_dwordx4 v6, s[12:15], s36 offen lds
    s_mov_b32 m0, 126976
    s_add_u32 s36, s48, 98816
    buffer_load_dwordx4 v4, s[8:11], s36 offen lds
    s_mov_b32 m0, 128000
    s_add_u32 s36, s48, 107008
    buffer_load_dwordx4 v5, s[8:11], s36 offen lds
    s_mov_b32 m0, 129024
    s_add_u32 s36, s48, 115200
    buffer_load_dwordx4 v4, s[8:11], s36 offen lds
    s_mov_b32 m0, 130048
    s_add_u32 s36, s48, 123392
    buffer_load_dwordx4 v5, s[8:11], s36 offen lds
    s_mov_b32 m0, 134144
    s_add_u32 s36, s35, 933888
    buffer_load_dwordx4 v6, s[12:15], s36 offen lds
    s_mov_b32 m0, 138240
    s_add_u32 s36, s35, 934912
    buffer_load_dwordx4 v6, s[12:15], s36 offen lds
    s_mov_b32 m0, 142336
    s_add_u32 s36, s35, 935936
    buffer_load_dwordx4 v6, s[12:15], s36 offen lds
    s_waitcnt vmcnt(28)
    s_barrier
    s_mov_b32 m0, 0
    s_add_u32 s36, s48, 640
    buffer_load_dwordx4 v4, s[8:11], s36 offen lds
    s_mov_b32 m0, 1024
    s_add_u32 s36, s48, 8832
    buffer_load_dwordx4 v5, s[8:11], s36 offen lds
    s_mov_b32 m0, 2048
    s_add_u32 s36, s48, 17024
    buffer_load_dwordx4 v4, s[8:11], s36 offen lds
    s_mov_b32 m0, 3072
    s_add_u32 s36, s48, 25216
    buffer_load_dwordx4 v5, s[8:11], s36 offen lds
    s_mov_b32 m0, 16384
    s_add_u32 s36, s35, 983040
    buffer_load_dwordx4 v6, s[12:15], s36 offen lds
    s_mov_b32 m0, 20480
    s_add_u32 s36, s35, 984064
    buffer_load_dwordx4 v6, s[12:15], s36 offen lds
    s_mov_b32 m0, 24576
    s_add_u32 s36, s35, 985088
    buffer_load_dwordx4 v6, s[12:15], s36 offen lds
    s_mov_b32 m0, 4096
    s_add_u32 s36, s48, 33408
    buffer_load_dwordx4 v4, s[8:11], s36 offen lds
    s_mov_b32 m0, 5120
    s_add_u32 s36, s48, 41600
    buffer_load_dwordx4 v5, s[8:11], s36 offen lds
    s_mov_b32 m0, 6144
    s_add_u32 s36, s48, 49792
    buffer_load_dwordx4 v4, s[8:11], s36 offen lds
    s_mov_b32 m0, 7168
    s_add_u32 s36, s48, 57984
    buffer_load_dwordx4 v5, s[8:11], s36 offen lds
    s_mov_b32 m0, 17408
    s_add_u32 s36, s35, 1032192
    buffer_load_dwordx4 v6, s[12:15], s36 offen lds
    s_mov_b32 m0, 21504
    s_add_u32 s36, s35, 1033216
    buffer_load_dwordx4 v6, s[12:15], s36 offen lds
    s_mov_b32 m0, 25600
    s_add_u32 s36, s35, 1034240
    buffer_load_dwordx4 v6, s[12:15], s36 offen lds
    s_mov_b32 m0, 8192
    s_add_u32 s36, s48, 66176
    buffer_load_dwordx4 v4, s[8:11], s36 offen lds
    s_mov_b32 m0, 9216
    s_add_u32 s36, s48, 74368
    buffer_load_dwordx4 v5, s[8:11], s36 offen lds
    s_mov_b32 m0, 10240
    s_add_u32 s36, s48, 82560
    buffer_load_dwordx4 v4, s[8:11], s36 offen lds
    s_mov_b32 m0, 11264
    s_add_u32 s36, s48, 90752
    buffer_load_dwordx4 v5, s[8:11], s36 offen lds
    s_mov_b32 m0, 18432
    s_add_u32 s36, s35, 1081344
    buffer_load_dwordx4 v6, s[12:15], s36 offen lds
    s_mov_b32 m0, 22528
    s_add_u32 s36, s35, 1082368
    buffer_load_dwordx4 v6, s[12:15], s36 offen lds
    s_mov_b32 m0, 26624
    s_add_u32 s36, s35, 1083392
    buffer_load_dwordx4 v6, s[12:15], s36 offen lds
    s_mov_b32 m0, 12288
    s_add_u32 s36, s48, 98944
    buffer_load_dwordx4 v4, s[8:11], s36 offen lds
    s_mov_b32 m0, 13312
    s_add_u32 s36, s48, 107136
    buffer_load_dwordx4 v5, s[8:11], s36 offen lds
    s_mov_b32 m0, 14336
    s_add_u32 s36, s48, 115328
    buffer_load_dwordx4 v4, s[8:11], s36 offen lds
    s_mov_b32 m0, 15360
    s_add_u32 s36, s48, 123520
    buffer_load_dwordx4 v5, s[8:11], s36 offen lds
    s_mov_b32 m0, 19456
    s_add_u32 s36, s35, 1130496
    buffer_load_dwordx4 v6, s[12:15], s36 offen lds
    s_mov_b32 m0, 23552
    s_add_u32 s36, s35, 1131520
    buffer_load_dwordx4 v6, s[12:15], s36 offen lds
    s_mov_b32 m0, 27648
    s_add_u32 s36, s35, 1132544
    buffer_load_dwordx4 v6, s[12:15], s36 offen lds
    s_waitcnt vmcnt(28)
    s_barrier
    s_mov_b32 m0, 28672
    s_add_u32 s36, s48, 768
    buffer_load_dwordx4 v4, s[8:11], s36 offen lds
    s_mov_b32 m0, 29696
    s_add_u32 s36, s48, 8960
    buffer_load_dwordx4 v5, s[8:11], s36 offen lds
    s_mov_b32 m0, 30720
    s_add_u32 s36, s48, 17152
    buffer_load_dwordx4 v4, s[8:11], s36 offen lds
    s_mov_b32 m0, 31744
    s_add_u32 s36, s48, 25344
    buffer_load_dwordx4 v5, s[8:11], s36 offen lds
    s_mov_b32 m0, 45056
    s_add_u32 s36, s35, 1179648
    buffer_load_dwordx4 v6, s[12:15], s36 offen lds
    s_mov_b32 m0, 49152
    s_add_u32 s36, s35, 1180672
    buffer_load_dwordx4 v6, s[12:15], s36 offen lds
    s_mov_b32 m0, 53248
    s_add_u32 s36, s35, 1181696
    buffer_load_dwordx4 v6, s[12:15], s36 offen lds
    s_mov_b32 m0, 32768
    s_add_u32 s36, s48, 33536
    buffer_load_dwordx4 v4, s[8:11], s36 offen lds
    s_mov_b32 m0, 33792
    s_add_u32 s36, s48, 41728
    buffer_load_dwordx4 v5, s[8:11], s36 offen lds
    s_mov_b32 m0, 34816
    s_add_u32 s36, s48, 49920
    buffer_load_dwordx4 v4, s[8:11], s36 offen lds
    s_mov_b32 m0, 35840
    s_add_u32 s36, s48, 58112
    buffer_load_dwordx4 v5, s[8:11], s36 offen lds
    s_mov_b32 m0, 46080
    s_add_u32 s36, s35, 1228800
    buffer_load_dwordx4 v6, s[12:15], s36 offen lds
    s_mov_b32 m0, 50176
    s_add_u32 s36, s35, 1229824
    buffer_load_dwordx4 v6, s[12:15], s36 offen lds
    s_mov_b32 m0, 54272
    s_add_u32 s36, s35, 1230848
    buffer_load_dwordx4 v6, s[12:15], s36 offen lds
    s_mov_b32 m0, 36864
    s_add_u32 s36, s48, 66304
    buffer_load_dwordx4 v4, s[8:11], s36 offen lds
    s_mov_b32 m0, 37888
    s_add_u32 s36, s48, 74496
    buffer_load_dwordx4 v5, s[8:11], s36 offen lds
    s_mov_b32 m0, 38912
    s_add_u32 s36, s48, 82688
    buffer_load_dwordx4 v4, s[8:11], s36 offen lds
    s_mov_b32 m0, 39936
    s_add_u32 s36, s48, 90880
    buffer_load_dwordx4 v5, s[8:11], s36 offen lds
    s_mov_b32 m0, 47104
    s_add_u32 s36, s35, 1277952
    buffer_load_dwordx4 v6, s[12:15], s36 offen lds
    s_mov_b32 m0, 51200
    s_add_u32 s36, s35, 1278976
    buffer_load_dwordx4 v6, s[12:15], s36 offen lds
    s_mov_b32 m0, 55296
    s_add_u32 s36, s35, 1280000
    buffer_load_dwordx4 v6, s[12:15], s36 offen lds
    s_mov_b32 m0, 40960
    s_add_u32 s36, s48, 99072
    buffer_load_dwordx4 v4, s[8:11], s36 offen lds
    s_mov_b32 m0, 41984
    s_add_u32 s36, s48, 107264
    buffer_load_dwordx4 v5, s[8:11], s36 offen lds
    s_mov_b32 m0, 43008
    s_add_u32 s36, s48, 115456
    buffer_load_dwordx4 v4, s[8:11], s36 offen lds
    s_mov_b32 m0, 44032
    s_add_u32 s36, s48, 123648
    buffer_load_dwordx4 v5, s[8:11], s36 offen lds
    s_mov_b32 m0, 48128
    s_add_u32 s36, s35, 1327104
    buffer_load_dwordx4 v6, s[12:15], s36 offen lds
    s_mov_b32 m0, 52224
    s_add_u32 s36, s35, 1328128
    buffer_load_dwordx4 v6, s[12:15], s36 offen lds
    s_mov_b32 m0, 56320
    s_add_u32 s36, s35, 1329152
    buffer_load_dwordx4 v6, s[12:15], s36 offen lds
    s_waitcnt vmcnt(28)
    s_barrier
    s_mov_b32 m0, 57344
    s_add_u32 s36, s48, 896
    buffer_load_dwordx4 v4, s[8:11], s36 offen lds
    s_mov_b32 m0, 58368
    s_add_u32 s36, s48, 9088
    buffer_load_dwordx4 v5, s[8:11], s36 offen lds
    s_mov_b32 m0, 59392
    s_add_u32 s36, s48, 17280
    buffer_load_dwordx4 v4, s[8:11], s36 offen lds
    s_mov_b32 m0, 60416
    s_add_u32 s36, s48, 25472
    buffer_load_dwordx4 v5, s[8:11], s36 offen lds
    s_mov_b32 m0, 73728
    s_add_u32 s36, s35, 1376256
    buffer_load_dwordx4 v6, s[12:15], s36 offen lds
    s_mov_b32 m0, 77824
    s_add_u32 s36, s35, 1377280
    buffer_load_dwordx4 v6, s[12:15], s36 offen lds
    s_mov_b32 m0, 81920
    s_add_u32 s36, s35, 1378304
    buffer_load_dwordx4 v6, s[12:15], s36 offen lds
    s_mov_b32 m0, 61440
    s_add_u32 s36, s48, 33664
    buffer_load_dwordx4 v4, s[8:11], s36 offen lds
    s_mov_b32 m0, 62464
    s_add_u32 s36, s48, 41856
    buffer_load_dwordx4 v5, s[8:11], s36 offen lds
    s_mov_b32 m0, 63488
    s_add_u32 s36, s48, 50048
    buffer_load_dwordx4 v4, s[8:11], s36 offen lds
    s_mov_b32 m0, 64512
    s_add_u32 s36, s48, 58240
    buffer_load_dwordx4 v5, s[8:11], s36 offen lds
    s_mov_b32 m0, 74752
    s_add_u32 s36, s35, 1425408
    buffer_load_dwordx4 v6, s[12:15], s36 offen lds
    s_mov_b32 m0, 78848
    s_add_u32 s36, s35, 1426432
    buffer_load_dwordx4 v6, s[12:15], s36 offen lds
    s_mov_b32 m0, 82944
    s_add_u32 s36, s35, 1427456
    buffer_load_dwordx4 v6, s[12:15], s36 offen lds
    s_mov_b32 m0, 65536
    s_add_u32 s36, s48, 66432
    buffer_load_dwordx4 v4, s[8:11], s36 offen lds
    s_mov_b32 m0, 66560
    s_add_u32 s36, s48, 74624
    buffer_load_dwordx4 v5, s[8:11], s36 offen lds
    s_mov_b32 m0, 67584
    s_add_u32 s36, s48, 82816
    buffer_load_dwordx4 v4, s[8:11], s36 offen lds
    s_mov_b32 m0, 68608
    s_add_u32 s36, s48, 91008
    buffer_load_dwordx4 v5, s[8:11], s36 offen lds
    s_mov_b32 m0, 75776
    s_add_u32 s36, s35, 1474560
    buffer_load_dwordx4 v6, s[12:15], s36 offen lds
    s_mov_b32 m0, 79872
    s_add_u32 s36, s35, 1475584
    buffer_load_dwordx4 v6, s[12:15], s36 offen lds
    s_mov_b32 m0, 83968
    s_add_u32 s36, s35, 1476608
    buffer_load_dwordx4 v6, s[12:15], s36 offen lds
    s_mov_b32 m0, 69632
    s_add_u32 s36, s48, 99200
    buffer_load_dwordx4 v4, s[8:11], s36 offen lds
    s_mov_b32 m0, 70656
    s_add_u32 s36, s48, 107392
    buffer_load_dwordx4 v5, s[8:11], s36 offen lds
    s_mov_b32 m0, 71680
    s_add_u32 s36, s48, 115584
    buffer_load_dwordx4 v4, s[8:11], s36 offen lds
    s_mov_b32 m0, 72704
    s_add_u32 s36, s48, 123776
    buffer_load_dwordx4 v5, s[8:11], s36 offen lds
    s_mov_b32 m0, 76800
    s_add_u32 s36, s35, 1523712
    buffer_load_dwordx4 v6, s[12:15], s36 offen lds
    s_mov_b32 m0, 80896
    s_add_u32 s36, s35, 1524736
    buffer_load_dwordx4 v6, s[12:15], s36 offen lds
    s_mov_b32 m0, 84992
    s_add_u32 s36, s35, 1525760
    buffer_load_dwordx4 v6, s[12:15], s36 offen lds
    s_waitcnt vmcnt(28)
    s_barrier
    s_waitcnt vmcnt(0)
    s_barrier
    s_load_dwordx2 s[52:53], s[0:1], 16
    v_lshlrev_b32 v8, 4, v1
    s_waitcnt lgkmcnt(0)
    s_mov_b32 s60, s52
    s_and_b32 s61, s53, 0xffff
    s_mov_b32 s62, 524288
    s_mov_b32 s63, 0x00020000
    s_lshl_b32 s36, s2, 11
    s_mov_b32 m0, 0
    s_add_u32 s37, s36, 1024
    buffer_load_dwordx4 v8, s[60:63], s36 offen lds
    s_mov_b32 m0, 1024
    s_nop 0
    buffer_load_dwordx4 v8, s[60:63], s37 offen lds
    s_endpgm
k1_compute:
    v_lshlrev_b32 v8, 4, v1
    s_and_b32 s36, s31, 7
    s_lshl_b32 s36, s36, 4
    s_add_u32 s36, s36, s33
    s_lshl_b32 s37, s32, 2
    s_add_u32 s36, s36, s37
    s_lshl_b32 s36, s36, 10
    buffer_load_dwordx4 v[204:207], v8, s[8:11], s36 offen offset:0
    buffer_load_dwordx4 v[204:207], v8, s[8:11], s36 offen offset:1024
    buffer_load_dwordx4 v[204:207], v8, s[8:11], s36 offen offset:2048
    buffer_load_dwordx4 v[204:207], v8, s[8:11], s36 offen offset:3072
    v_lshrrev_b32 v10, 2, v1
    v_mul_u32_u24 v9, 3072, v10
    v_and_b32 v10, 3, v1
    v_lshl_add_u32 v9, v10, 4, v9
    s_and_b32 s36, s30, 3
    s_lshl_b32 s36, s36, 7
    s_lshl_b32 s37, s32, 5
    s_add_u32 s36, s36, s37
    s_mul_i32 s36, s36, 3072
    s_lshl_b32 s37, s31, 6
    s_add_u32 s36, s36, s37
    s_add_u32 s37, s36, 0
    buffer_load_dwordx4 v[204:207], v9, s[12:15], s37 offen
    s_add_u32 s37, s36, 1024
    buffer_load_dwordx4 v[204:207], v9, s[12:15], s37 offen
    s_add_u32 s37, s36, 2048
    buffer_load_dwordx4 v[204:207], v9, s[12:15], s37 offen
    s_add_u32 s37, s36, 49152
    buffer_load_dwordx4 v[204:207], v9, s[12:15], s37 offen
    s_add_u32 s37, s36, 50176
    buffer_load_dwordx4 v[204:207], v9, s[12:15], s37 offen
    s_add_u32 s37, s36, 51200
    buffer_load_dwordx4 v[204:207], v9, s[12:15], s37 offen
    v_lshrrev_b32 v8, 5, v1
    v_lshlrev_b32 v8, 3, v8
    v_bfe_u32 v9, v1, 2, 2
    v_add_u32 v8, v8, v9
    v_lshlrev_b32 v7, 6, v8
    v_bfe_u32 v9, v1, 4, 1
    v_lshl_add_u32 v7, v9, 5, v7
    v_and_b32 v9, 3, v1
    v_lshl_add_u32 v7, v9, 3, v7
    v_add_u32 v8, s34, v2
    v_bfe_u32 v9, v8, 1, 3
    v_xor_b32 v9, v9, v3
    v_lshlrev_b32 v8, 7, v8
    v_xor_b32 v10, 0, v9
    v_lshl_add_u32 v46, v10, 4, v8
    v_xor_b32 v10, 2, v9
    v_lshl_add_u32 v47, v10, 4, v8
    v_xor_b32 v10, 4, v9
    v_lshl_add_u32 v48, v10, 4, v8
    v_xor_b32 v10, 6, v9
    v_lshl_add_u32 v49, v10, 4, v8
    v_add_u32 v136, 0, v7
    v_add_u32 v144, 0, v46
    v_add_u32 v145, 0, v47
    v_add_u32 v146, 0, v48
    v_add_u32 v147, 0, v49
    v_add_u32 v137, 28672, v7
    v_add_u32 v148, 28672, v46
    v_add_u32 v149, 28672, v47
    v_add_u32 v150, 28672, v48
    v_add_u32 v151, 28672, v49
    v_add_u32 v138, 57344, v7
    v_add_u32 v152, 57344, v46
    v_add_u32 v153, 57344, v47
    v_add_u32 v154, 57344, v48
    v_add_u32 v155, 57344, v49
    v_add_u32 v139, 86016, v7
    v_add_u32 v156, 86016, v46
    v_add_u32 v157, 86016, v47
    v_add_u32 v158, 86016, v48
    v_add_u32 v159, 86016, v49
    v_add_u32 v140, 114688, v7
    v_add_u32 v160, 114688, v46
    v_add_u32 v161, 114688, v47
    v_add_u32 v162, 114688, v48
    v_add_u32 v163, 114688, v49
    v_mov_b32 v45, 0x3f803f80
    v_mov_b32 v40, 0
    v_mov_b32 v41, 0
    v_mov_b32 v42, 0
    v_mov_b32 v43, 0
    v_mov_b32 v44, 0
    v_mov_b32 v64, 0
    v_mov_b32 v65, 0
    v_mov_b32 v66, 0
    v_mov_b32 v67, 0
    v_mov_b32 v68, 0
    v_mov_b32 v69, 0
    v_mov_b32 v70, 0
    v_mov_b32 v71, 0
    v_mov_b32 v72, 0
    v_mov_b32 v73, 0
    v_mov_b32 v74, 0
    v_mov_b32 v75, 0
    v_mov_b32 v76, 0
    v_mov_b32 v77, 0
    v_mov_b32 v78, 0
    v_mov_b32 v79, 0
    v_mov_b32 v80, 0
    v_mov_b32 v81, 0
    v_mov_b32 v82, 0
    v_mov_b32 v83, 0
    v_mov_b32 v84, 0
    v_mov_b32 v85, 0
    v_mov_b32 v86, 0
    v_mov_b32 v87, 0
    v_mov_b32 v88, 0
    v_mov_b32 v89, 0
    v_mov_b32 v90, 0
    v_mov_b32 v91, 0
    v_mov_b32 v92, 0
    v_mov_b32 v93, 0
    v_mov_b32 v94, 0
    v_mov_b32 v95, 0
    v_mov_b32 v96, 0
    v_mov_b32 v97, 0
    v_mov_b32 v98, 0
    v_mov_b32 v99, 0
    v_mov_b32 v100, 0
    v_mov_b32 v101, 0
    v_mov_b32 v102, 0
    v_mov_b32 v103, 0
    v_mov_b32 v104, 0
    v_mov_b32 v105, 0
    v_mov_b32 v106, 0
    v_mov_b32 v107, 0
    v_mov_b32 v108, 0
    v_mov_b32 v109, 0
    v_mov_b32 v110, 0
    v_mov_b32 v111, 0
    v_mov_b32 v112, 0
    v_mov_b32 v113, 0
    v_mov_b32 v114, 0
    v_mov_b32 v115, 0
    v_mov_b32 v116, 0
    v_mov_b32 v117, 0
    v_mov_b32 v118, 0
    v_mov_b32 v119, 0
    v_mov_b32 v120, 0
    v_mov_b32 v121, 0
    v_mov_b32 v122, 0
    v_mov_b32 v123, 0
    v_mov_b32 v124, 0
    v_mov_b32 v125, 0
    v_mov_b32 v126, 0
    v_mov_b32 v127, 0
    v_mov_b32 v128, 0
    v_mov_b32 v129, 0
    v_mov_b32 v130, 0
    v_mov_b32 v131, 0
    s_barrier
    ds_read_b128 v[52:55], v144
    ds_read_b64_tr_b16 v[16:17], v136 offset:16384
    ds_read_b64_tr_b16 v[18:19], v136 offset:16640
    ds_read_b64_tr_b16 v[20:21], v136 offset:20480
    ds_read_b64_tr_b16 v[22:23], v136 offset:20736
    ds_read_b64_tr_b16 v[24:25], v136 offset:24576
    ds_read_b64_tr_b16 v[26:27], v136 offset:24832
    s_waitcnt lgkmcnt(0)
    v_mfma_f32_32x32x16_bf16 v[80:95], v[52:55], v[20:23], v[80:95]
    ds_read_b128 v[56:59], v145
    ds_read_b64_tr_b16 v[28:29], v136 offset:17408
    ds_read_b64_tr_b16 v[30:31], v136 offset:17664
    v_dot2_f32_bf16 v112, v52, v45, v112
    v_dot2_f32_bf16 v113, v53, v45, v113
    v_dot2_f32_bf16 v114, v54, v45, v114
    v_dot2_f32_bf16 v115, v55, v45, v115
    v_mfma_f32_32x32x16_bf16 v[96:111], v[52:55], v[24:27], v[96:111]
    ds_read_b64_tr_b16 v[32:33], v136 offset:21504
    ds_read_b64_tr_b16 v[34:35], v136 offset:21760
    v_dot2_f32_bf16 v116, v52, v52, v116
    v_dot2_f32_bf16 v117, v53, v53, v117
    v_dot2_f32_bf16 v118, v54, v54, v118
    v_dot2_f32_bf16 v119, v55, v55, v119
    v_mfma_f32_32x32x16_bf16 v[64:79], v[16:19], v[52:55], v[64:79]
    ds_read_b64_tr_b16 v[36:37], v136 offset:25600
    ds_read_b64_tr_b16 v[38:39], v136 offset:25856
    s_cmp_lg_u32 s32, 0
    s_cbranch_scc1 k1_cs0
    v_dot2_f32_bf16 v120, v16, v45, v120
    v_dot2_f32_bf16 v121, v17, v45, v121
    v_dot2_f32_bf16 v122, v18, v45, v122
    v_dot2_f32_bf16 v123, v19, v45, v123
    v_dot2_f32_bf16 v124, v20, v45, v124
    v_dot2_f32_bf16 v125, v21, v45, v125
    v_dot2_f32_bf16 v126, v22, v45, v126
    v_dot2_f32_bf16 v127, v23, v45, v127
    v_dot2_f32_bf16 v128, v24, v45, v128
    v_dot2_f32_bf16 v129, v25, v45, v129
    v_dot2_f32_bf16 v130, v26, v45, v130
    v_dot2_f32_bf16 v131, v27, v45, v131
k1_cs0:
    s_waitcnt lgkmcnt(0)
    v_mfma_f32_32x32x16_bf16 v[80:95], v[56:59], v[32:35], v[80:95]
    ds_read_b128 v[52:55], v146
    ds_read_b64_tr_b16 v[16:17], v136 offset:18432
    ds_read_b64_tr_b16 v[18:19], v136 offset:18688
    v_dot2_f32_bf16 v112, v56, v45, v112
    v_dot2_f32_bf16 v113, v57, v45, v113
    v_dot2_f32_bf16 v114, v58, v45, v114
    v_dot2_f32_bf16 v115, v59, v45, v115
    v_mfma_f32_32x32x16_bf16 v[96:111], v[56:59], v[36:39], v[96:111]
    ds_read_b64_tr_b16 v[20:21], v136 offset:22528
    ds_read_b64_tr_b16 v[22:23], v136 offset:22784
    v_dot2_f32_bf16 v116, v56, v56, v116
    v_dot2_f32_bf16 v117, v57, v57, v117
    v_dot2_f32_bf16 v118, v58, v58, v118
    v_dot2_f32_bf16 v119, v59, v59, v119
    v_mfma_f32_32x32x16_bf16 v[64:79], v[28:31], v[56:59], v[64:79]
    ds_read_b64_tr_b16 v[24:25], v136 offset:26624
    ds_read_b64_tr_b16 v[26:27], v136 offset:26880
    s_cmp_lg_u32 s32, 1
    s_cbranch_scc1 k1_cs1
    v_dot2_f32_bf16 v120, v28, v45, v120
    v_dot2_f32_bf16 v121, v29, v45, v121
    v_dot2_f32_bf16 v122, v30, v45, v122
    v_dot2_f32_bf16 v123, v31, v45, v123
    v_dot2_f32_bf16 v124, v32, v45, v124
    v_dot2_f32_bf16 v125, v33, v45, v125
    v_dot2_f32_bf16 v126, v34, v45, v126
    v_dot2_f32_bf16 v127, v35, v45, v127
    v_dot2_f32_bf16 v128, v36, v45, v128
    v_dot2_f32_bf16 v129, v37, v45, v129
    v_dot2_f32_bf16 v130, v38, v45, v130
    v_dot2_f32_bf16 v131, v39, v45, v131
k1_cs1:
    s_waitcnt lgkmcnt(0)
    v_mfma_f32_32x32x16_bf16 v[80:95], v[52:55], v[20:23], v[80:95]
    ds_read_b128 v[56:59], v147
    ds_read_b64_tr_b16 v[28:29], v136 offset:19456
    ds_read_b64_tr_b16 v[30:31], v136 offset:19712
    v_dot2_f32_bf16 v112, v52, v45, v112
    v_dot2_f32_bf16 v113, v53, v45, v113
    v_dot2_f32_bf16 v114, v54, v45, v114
    v_dot2_f32_bf16 v115, v55, v45, v115
    v_mfma_f32_32x32x16_bf16 v[96:111], v[52:55], v[24:27], v[96:111]
    ds_read_b64_tr_b16 v[32:33], v136 offset:23552
    ds_read_b64_tr_b16 v[34:35], v136 offset:23808
    v_dot2_f32_bf16 v116, v52, v52, v116
    v_dot2_f32_bf16 v117, v53, v53, v117
    v_dot2_f32_bf16 v118, v54, v54, v118
    v_dot2_f32_bf16 v119, v55, v55, v119
    v_mfma_f32_32x32x16_bf16 v[64:79], v[16:19], v[52:55], v[64:79]
    ds_read_b64_tr_b16 v[36:37], v136 offset:27648
    ds_read_b64_tr_b16 v[38:39], v136 offset:27904
    s_cmp_lg_u32 s32, 2
    s_cbranch_scc1 k1_cs2
    v_dot2_f32_bf16 v120, v16, v45, v120
    v_dot2_f32_bf16 v121, v17, v45, v121
    v_dot2_f32_bf16 v122, v18, v45, v122
    v_dot2_f32_bf16 v123, v19, v45, v123
    v_dot2_f32_bf16 v124, v20, v45, v124
    v_dot2_f32_bf16 v125, v21, v45, v125
    v_dot2_f32_bf16 v126, v22, v45, v126
    v_dot2_f32_bf16 v127, v23, v45, v127
    v_dot2_f32_bf16 v128, v24, v45, v128
    v_dot2_f32_bf16 v129, v25, v45, v129
    v_dot2_f32_bf16 v130, v26, v45, v130
    v_dot2_f32_bf16 v131, v27, v45, v131
k1_cs2:
    s_waitcnt lgkmcnt(0)
    s_barrier
    v_mfma_f32_32x32x16_bf16 v[80:95], v[56:59], v[32:35], v[80:95]
    ds_read_b128 v[52:55], v148
    ds_read_b64_tr_b16 v[16:17], v137 offset:16384
    ds_read_b64_tr_b16 v[18:19], v137 offset:16640
    v_dot2_f32_bf16 v112, v56, v45, v112
    v_dot2_f32_bf16 v113, v57, v45, v113
    v_dot2_f32_bf16 v114, v58, v45, v114
    v_dot2_f32_bf16 v115, v59, v45, v115
    v_mfma_f32_32x32x16_bf16 v[96:111], v[56:59], v[36:39], v[96:111]
    ds_read_b64_tr_b16 v[20:21], v137 offset:20480
    ds_read_b64_tr_b16 v[22:23], v137 offset:20736
    v_dot2_f32_bf16 v116, v56, v56, v116
    v_dot2_f32_bf16 v117, v57, v57, v117
    v_dot2_f32_bf16 v118, v58, v58, v118
    v_dot2_f32_bf16 v119, v59, v59, v119
    v_mfma_f32_32x32x16_bf16 v[64:79], v[28:31], v[56:59], v[64:79]
    ds_read_b64_tr_b16 v[24:25], v137 offset:24576
    ds_read_b64_tr_b16 v[26:27], v137 offset:24832
    s_cmp_lg_u32 s32, 3
    s_cbranch_scc1 k1_cs3
    v_dot2_f32_bf16 v120, v28, v45, v120
    v_dot2_f32_bf16 v121, v29, v45, v121
    v_dot2_f32_bf16 v122, v30, v45, v122
    v_dot2_f32_bf16 v123, v31, v45, v123
    v_dot2_f32_bf16 v124, v32, v45, v124
    v_dot2_f32_bf16 v125, v33, v45, v125
    v_dot2_f32_bf16 v126, v34, v45, v126
    v_dot2_f32_bf16 v127, v35, v45, v127
    v_dot2_f32_bf16 v128, v36, v45, v128
    v_dot2_f32_bf16 v129, v37, v45, v129
    v_dot2_f32_bf16 v130, v38, v45, v130
    v_dot2_f32_bf16 v131, v39, v45, v131
k1_cs3:
    s_waitcnt lgkmcnt(0)
    v_mfma_f32_32x32x16_bf16 v[80:95], v[52:55], v[20:23], v[80:95]
    ds_read_b128 v[56:59], v149
    ds_read_b64_tr_b16 v[28:29], v137 offset:17408
    ds_read_b64_tr_b16 v[30:31], v137 offset:17664
    v_dot2_f32_bf16 v112, v52, v45, v112
    v_dot2_f32_bf16 v113, v53, v45, v113
    v_dot2_f32_bf16 v114, v54, v45, v114
    v_dot2_f32_bf16 v115, v55, v45, v115
    v_mfma_f32_32x32x16_bf16 v[96:111], v[52:55], v[24:27], v[96:111]
    ds_read_b64_tr_b16 v[32:33], v137 offset:21504
    ds_read_b64_tr_b16 v[34:35], v137 offset:21760
    v_dot2_f32_bf16 v116, v52, v52, v116
    v_dot2_f32_bf16 v117, v53, v53, v117
    v_dot2_f32_bf16 v118, v54, v54, v118
    v_dot2_f32_bf16 v119, v55, v55, v119
    v_mfma_f32_32x32x16_bf16 v[64:79], v[16:19], v[52:55], v[64:79]
    ds_read_b64_tr_b16 v[36:37], v137 offset:25600
    ds_read_b64_tr_b16 v[38:39], v137 offset:25856
    s_cmp_lg_u32 s32, 0
    s_cbranch_scc1 k1_cs4
    v_dot2_f32_bf16 v120, v16, v45, v120
    v_dot2_f32_bf16 v121, v17, v45, v121
    v_dot2_f32_bf16 v122, v18, v45, v122
    v_dot2_f32_bf16 v123, v19, v45, v123
    v_dot2_f32_bf16 v124, v20, v45, v124
    v_dot2_f32_bf16 v125, v21, v45, v125
    v_dot2_f32_bf16 v126, v22, v45, v126
    v_dot2_f32_bf16 v127, v23, v45, v127
    v_dot2_f32_bf16 v128, v24, v45, v128
    v_dot2_f32_bf16 v129, v25, v45, v129
    v_dot2_f32_bf16 v130, v26, v45, v130
    v_dot2_f32_bf16 v131, v27, v45, v131
k1_cs4:
    s_waitcnt lgkmcnt(0)
    v_mfma_f32_32x32x16_bf16 v[80:95], v[56:59], v[32:35], v[80:95]
    ds_read_b128 v[52:55], v150
    ds_read_b64_tr_b16 v[16:17], v137 offset:18432
    ds_read_b64_tr_b16 v[18:19], v137 offset:18688
    v_dot2_f32_bf16 v112, v56, v45, v112
    v_dot2_f32_bf16 v113, v57, v45, v113
    v_dot2_f32_bf16 v114, v58, v45, v114
    v_dot2_f32_bf16 v115, v59, v45, v115
    v_mfma_f32_32x32x16_bf16 v[96:111], v[56:59], v[36:39], v[96:111]
    ds_read_b64_tr_b16 v[20:21], v137 offset:22528
    ds_read_b64_tr_b16 v[22:23], v137 offset:22784
    v_dot2_f32_bf16 v116, v56, v56, v116
    v_dot2_f32_bf16 v117, v57, v57, v117
    v_dot2_f32_bf16 v118, v58, v58, v118
    v_dot2_f32_bf16 v119, v59, v59, v119
    v_mfma_f32_32x32x16_bf16 v[64:79], v[28:31], v[56:59], v[64:79]
    ds_read_b64_tr_b16 v[24:25], v137 offset:26624
    ds_read_b64_tr_b16 v[26:27], v137 offset:26880
    s_cmp_lg_u32 s32, 1
    s_cbranch_scc1 k1_cs5
    v_dot2_f32_bf16 v120, v28, v45, v120
    v_dot2_f32_bf16 v121, v29, v45, v121
    v_dot2_f32_bf16 v122, v30, v45, v122
    v_dot2_f32_bf16 v123, v31, v45, v123
    v_dot2_f32_bf16 v124, v32, v45, v124
    v_dot2_f32_bf16 v125, v33, v45, v125
    v_dot2_f32_bf16 v126, v34, v45, v126
    v_dot2_f32_bf16 v127, v35, v45, v127
    v_dot2_f32_bf16 v128, v36, v45, v128
    v_dot2_f32_bf16 v129, v37, v45, v129
    v_dot2_f32_bf16 v130, v38, v45, v130
    v_dot2_f32_bf16 v131, v39, v45, v131
k1_cs5:
    s_waitcnt lgkmcnt(0)
    v_mfma_f32_32x32x16_bf16 v[80:95], v[52:55], v[20:23], v[80:95]
    ds_read_b128 v[56:59], v151
    ds_read_b64_tr_b16 v[28:29], v137 offset:19456
    ds_read_b64_tr_b16 v[30:31], v137 offset:19712
    v_dot2_f32_bf16 v112, v52, v45, v112
    v_dot2_f32_bf16 v113, v53, v45, v113
    v_dot2_f32_bf16 v114, v54, v45, v114
    v_dot2_f32_bf16 v115, v55, v45, v115
    v_mfma_f32_32x32x16_bf16 v[96:111], v[52:55], v[24:27], v[96:111]
    ds_read_b64_tr_b16 v[32:33], v137 offset:23552
    ds_read_b64_tr_b16 v[34:35], v137 offset:23808
    v_dot2_f32_bf16 v116, v52, v52, v116
    v_dot2_f32_bf16 v117, v53, v53, v117
    v_dot2_f32_bf16 v118, v54, v54, v118
    v_dot2_f32_bf16 v119, v55, v55, v119
    v_mfma_f32_32x32x16_bf16 v[64:79], v[16:19], v[52:55], v[64:79]
    ds_read_b64_tr_b16 v[36:37], v137 offset:27648
    ds_read_b64_tr_b16 v[38:39], v137 offset:27904
    s_cmp_lg_u32 s32, 2
    s_cbranch_scc1 k1_cs6
    v_dot2_f32_bf16 v120, v16, v45, v120
    v_dot2_f32_bf16 v121, v17, v45, v121
    v_dot2_f32_bf16 v122, v18, v45, v122
    v_dot2_f32_bf16 v123, v19, v45, v123
    v_dot2_f32_bf16 v124, v20, v45, v124
    v_dot2_f32_bf16 v125, v21, v45, v125
    v_dot2_f32_bf16 v126, v22, v45, v126
    v_dot2_f32_bf16 v127, v23, v45, v127
    v_dot2_f32_bf16 v128, v24, v45, v128
    v_dot2_f32_bf16 v129, v25, v45, v129
    v_dot2_f32_bf16 v130, v26, v45, v130
    v_dot2_f32_bf16 v131, v27, v45, v131
k1_cs6:
    s_waitcnt lgkmcnt(0)
    s_barrier
    v_mfma_f32_32x32x16_bf16 v[80:95], v[56:59], v[32:35], v[80:95]
    ds_read_b128 v[52:55], v152
    ds_read_b64_tr_b16 v[16:17], v138 offset:16384
    ds_read_b64_tr_b16 v[18:19], v138 offset:16640
    v_dot2_f32_bf16 v112, v56, v45, v112
    v_dot2_f32_bf16 v113, v57, v45, v113
    v_dot2_f32_bf16 v114, v58, v45, v114
    v_dot2_f32_bf16 v115, v59, v45, v115
    v_mfma_f32_32x32x16_bf16 v[96:111], v[56:59], v[36:39], v[96:111]
    ds_read_b64_tr_b16 v[20:21], v138 offset:20480
    ds_read_b64_tr_b16 v[22:23], v138 offset:20736
    v_dot2_f32_bf16 v116, v56, v56, v116
    v_dot2_f32_bf16 v117, v57, v57, v117
    v_dot2_f32_bf16 v118, v58, v58, v118
    v_dot2_f32_bf16 v119, v59, v59, v119
    v_mfma_f32_32x32x16_bf16 v[64:79], v[28:31], v[56:59], v[64:79]
    ds_read_b64_tr_b16 v[24:25], v138 offset:24576
    ds_read_b64_tr_b16 v[26:27], v138 offset:24832
    s_cmp_lg_u32 s32, 3
    s_cbranch_scc1 k1_cs7
    v_dot2_f32_bf16 v120, v28, v45, v120
    v_dot2_f32_bf16 v121, v29, v45, v121
    v_dot2_f32_bf16 v122, v30, v45, v122
    v_dot2_f32_bf16 v123, v31, v45, v123
    v_dot2_f32_bf16 v124, v32, v45, v124
    v_dot2_f32_bf16 v125, v33, v45, v125
    v_dot2_f32_bf16 v126, v34, v45, v126
    v_dot2_f32_bf16 v127, v35, v45, v127
    v_dot2_f32_bf16 v128, v36, v45, v128
    v_dot2_f32_bf16 v129, v37, v45, v129
    v_dot2_f32_bf16 v130, v38, v45, v130
    v_dot2_f32_bf16 v131, v39, v45, v131
k1_cs7:
    s_waitcnt lgkmcnt(0)
    v_mfma_f32_32x32x16_bf16 v[80:95], v[52:55], v[20:23], v[80:95]
    ds_read_b128 v[56:59], v153
    ds_read_b64_tr_b16 v[28:29], v138 offset:17408
    ds_read_b64_tr_b16 v[30:31], v138 offset:17664
    v_dot2_f32_bf16 v112, v52, v45, v112
    v_dot2_f32_bf16 v113, v53, v45, v113
    v_dot2_f32_bf16 v114, v54, v45, v114
    v_dot2_f32_bf16 v115, v55, v45, v115
    v_mfma_f32_32x32x16_bf16 v[96:111], v[52:55], v[24:27], v[96:111]
    ds_read_b64_tr_b16 v[32:33], v138 offset:21504
    ds_read_b64_tr_b16 v[34:35], v138 offset:21760
    v_dot2_f32_bf16 v116, v52, v52, v116
    v_dot2_f32_bf16 v117, v53, v53, v117
    v_dot2_f32_bf16 v118, v54, v54, v118
    v_dot2_f32_bf16 v119, v55, v55, v119
    v_mfma_f32_32x32x16_bf16 v[64:79], v[16:19], v[52:55], v[64:79]
    ds_read_b64_tr_b16 v[36:37], v138 offset:25600
    ds_read_b64_tr_b16 v[38:39], v138 offset:25856
    s_cmp_lg_u32 s32, 0
    s_cbranch_scc1 k1_cs8
    v_dot2_f32_bf16 v120, v16, v45, v120
    v_dot2_f32_bf16 v121, v17, v45, v121
    v_dot2_f32_bf16 v122, v18, v45, v122
    v_dot2_f32_bf16 v123, v19, v45, v123
    v_dot2_f32_bf16 v124, v20, v45, v124
    v_dot2_f32_bf16 v125, v21, v45, v125
    v_dot2_f32_bf16 v126, v22, v45, v126
    v_dot2_f32_bf16 v127, v23, v45, v127
    v_dot2_f32_bf16 v128, v24, v45, v128
    v_dot2_f32_bf16 v129, v25, v45, v129
    v_dot2_f32_bf16 v130, v26, v45, v130
    v_dot2_f32_bf16 v131, v27, v45, v131
k1_cs8:
    s_waitcnt lgkmcnt(0)
    v_mfma_f32_32x32x16_bf16 v[80:95], v[56:59], v[32:35], v[80:95]
    ds_read_b128 v[52:55], v154
    ds_read_b64_tr_b16 v[16:17], v138 offset:18432
    ds_read_b64_tr_b16 v[18:19], v138 offset:18688
    v_dot2_f32_bf16 v112, v56, v45, v112
    v_dot2_f32_bf16 v113, v57, v45, v113
    v_dot2_f32_bf16 v114, v58, v45, v114
    v_dot2_f32_bf16 v115, v59, v45, v115
    v_mfma_f32_32x32x16_bf16 v[96:111], v[56:59], v[36:39], v[96:111]
    ds_read_b64_tr_b16 v[20:21], v138 offset:22528
    ds_read_b64_tr_b16 v[22:23], v138 offset:22784
    v_dot2_f32_bf16 v116, v56, v56, v116
    v_dot2_f32_bf16 v117, v57, v57, v117
    v_dot2_f32_bf16 v118, v58, v58, v118
    v_dot2_f32_bf16 v119, v59, v59, v119
    v_mfma_f32_32x32x16_bf16 v[64:79], v[28:31], v[56:59], v[64:79]
    ds_read_b64_tr_b16 v[24:25], v138 offset:26624
    ds_read_b64_tr_b16 v[26:27], v138 offset:26880
    s_cmp_lg_u32 s32, 1
    s_cbranch_scc1 k1_cs9
    v_dot2_f32_bf16 v120, v28, v45, v120
    v_dot2_f32_bf16 v121, v29, v45, v121
    v_dot2_f32_bf16 v122, v30, v45, v122
    v_dot2_f32_bf16 v123, v31, v45, v123
    v_dot2_f32_bf16 v124, v32, v45, v124
    v_dot2_f32_bf16 v125, v33, v45, v125
    v_dot2_f32_bf16 v126, v34, v45, v126
    v_dot2_f32_bf16 v127, v35, v45, v127
    v_dot2_f32_bf16 v128, v36, v45, v128
    v_dot2_f32_bf16 v129, v37, v45, v129
    v_dot2_f32_bf16 v130, v38, v45, v130
    v_dot2_f32_bf16 v131, v39, v45, v131
k1_cs9:
    s_waitcnt lgkmcnt(0)
    v_mfma_f32_32x32x16_bf16 v[80:95], v[52:55], v[20:23], v[80:95]
    ds_read_b128 v[56:59], v155
    ds_read_b64_tr_b16 v[28:29], v138 offset:19456
    ds_read_b64_tr_b16 v[30:31], v138 offset:19712
    v_dot2_f32_bf16 v112, v52, v45, v112
    v_dot2_f32_bf16 v113, v53, v45, v113
    v_dot2_f32_bf16 v114, v54, v45, v114
    v_dot2_f32_bf16 v115, v55, v45, v115
    v_mfma_f32_32x32x16_bf16 v[96:111], v[52:55], v[24:27], v[96:111]
    ds_read_b64_tr_b16 v[32:33], v138 offset:23552
    ds_read_b64_tr_b16 v[34:35], v138 offset:23808
    v_dot2_f32_bf16 v116, v52, v52, v116
    v_dot2_f32_bf16 v117, v53, v53, v117
    v_dot2_f32_bf16 v118, v54, v54, v118
    v_dot2_f32_bf16 v119, v55, v55, v119
    v_mfma_f32_32x32x16_bf16 v[64:79], v[16:19], v[52:55], v[64:79]
    ds_read_b64_tr_b16 v[36:37], v138 offset:27648
    ds_read_b64_tr_b16 v[38:39], v138 offset:27904
    s_cmp_lg_u32 s32, 2
    s_cbranch_scc1 k1_cs10
    v_dot2_f32_bf16 v120, v16, v45, v120
    v_dot2_f32_bf16 v121, v17, v45, v121
    v_dot2_f32_bf16 v122, v18, v45, v122
    v_dot2_f32_bf16 v123, v19, v45, v123
    v_dot2_f32_bf16 v124, v20, v45, v124
    v_dot2_f32_bf16 v125, v21, v45, v125
    v_dot2_f32_bf16 v126, v22, v45, v126
    v_dot2_f32_bf16 v127, v23, v45, v127
    v_dot2_f32_bf16 v128, v24, v45, v128
    v_dot2_f32_bf16 v129, v25, v45, v129
    v_dot2_f32_bf16 v130, v26, v45, v130
    v_dot2_f32_bf16 v131, v27, v45, v131
k1_cs10:
    s_waitcnt lgkmcnt(0)
    s_barrier
    v_mfma_f32_32x32x16_bf16 v[80:95], v[56:59], v[32:35], v[80:95]
    ds_read_b128 v[52:55], v156
    ds_read_b64_tr_b16 v[16:17], v139 offset:16384
    ds_read_b64_tr_b16 v[18:19], v139 offset:16640
    v_dot2_f32_bf16 v112, v56, v45, v112
    v_dot2_f32_bf16 v113, v57, v45, v113
    v_dot2_f32_bf16 v114, v58, v45, v114
    v_dot2_f32_bf16 v115, v59, v45, v115
    v_mfma_f32_32x32x16_bf16 v[96:111], v[56:59], v[36:39], v[96:111]
    ds_read_b64_tr_b16 v[20:21], v139 offset:20480
    ds_read_b64_tr_b16 v[22:23], v139 offset:20736
    v_dot2_f32_bf16 v116, v56, v56, v116
    v_dot2_f32_bf16 v117, v57, v57, v117
    v_dot2_f32_bf16 v118, v58, v58, v118
    v_dot2_f32_bf16 v119, v59, v59, v119
    v_mfma_f32_32x32x16_bf16 v[64:79], v[28:31], v[56:59], v[64:79]
    ds_read_b64_tr_b16 v[24:25], v139 offset:24576
    ds_read_b64_tr_b16 v[26:27], v139 offset:24832
    s_cmp_lg_u32 s32, 3
    s_cbranch_scc1 k1_cs11
    v_dot2_f32_bf16 v120, v28, v45, v120
    v_dot2_f32_bf16 v121, v29, v45, v121
    v_dot2_f32_bf16 v122, v30, v45, v122
    v_dot2_f32_bf16 v123, v31, v45, v123
    v_dot2_f32_bf16 v124, v32, v45, v124
    v_dot2_f32_bf16 v125, v33, v45, v125
    v_dot2_f32_bf16 v126, v34, v45, v126
    v_dot2_f32_bf16 v127, v35, v45, v127
    v_dot2_f32_bf16 v128, v36, v45, v128
    v_dot2_f32_bf16 v129, v37, v45, v129
    v_dot2_f32_bf16 v130, v38, v45, v130
    v_dot2_f32_bf16 v131, v39, v45, v131
k1_cs11:
    s_waitcnt lgkmcnt(0)
    v_mfma_f32_32x32x16_bf16 v[80:95], v[52:55], v[20:23], v[80:95]
    ds_read_b128 v[56:59], v157
    ds_read_b64_tr_b16 v[28:29], v139 offset:17408
    ds_read_b64_tr_b16 v[30:31], v139 offset:17664
    v_dot2_f32_bf16 v112, v52, v45, v112
    v_dot2_f32_bf16 v113, v53, v45, v113
    v_dot2_f32_bf16 v114, v54, v45, v114
    v_dot2_f32_bf16 v115, v55, v45, v115
    v_mfma_f32_32x32x16_bf16 v[96:111], v[52:55], v[24:27], v[96:111]
    ds_read_b64_tr_b16 v[32:33], v139 offset:21504
    ds_read_b64_tr_b16 v[34:35], v139 offset:21760
    v_dot2_f32_bf16 v116, v52, v52, v116
    v_dot2_f32_bf16 v117, v53, v53, v117
    v_dot2_f32_bf16 v118, v54, v54, v118
    v_dot2_f32_bf16 v119, v55, v55, v119
    v_mfma_f32_32x32x16_bf16 v[64:79], v[16:19], v[52:55], v[64:79]
    ds_read_b64_tr_b16 v[36:37], v139 offset:25600
    ds_read_b64_tr_b16 v[38:39], v139 offset:25856
    s_cmp_lg_u32 s32, 0
    s_cbranch_scc1 k1_cs12
    v_dot2_f32_bf16 v120, v16, v45, v120
    v_dot2_f32_bf16 v121, v17, v45, v121
    v_dot2_f32_bf16 v122, v18, v45, v122
    v_dot2_f32_bf16 v123, v19, v45, v123
    v_dot2_f32_bf16 v124, v20, v45, v124
    v_dot2_f32_bf16 v125, v21, v45, v125
    v_dot2_f32_bf16 v126, v22, v45, v126
    v_dot2_f32_bf16 v127, v23, v45, v127
    v_dot2_f32_bf16 v128, v24, v45, v128
    v_dot2_f32_bf16 v129, v25, v45, v129
    v_dot2_f32_bf16 v130, v26, v45, v130
    v_dot2_f32_bf16 v131, v27, v45, v131
k1_cs12:
    s_waitcnt lgkmcnt(0)
    v_mfma_f32_32x32x16_bf16 v[80:95], v[56:59], v[32:35], v[80:95]
    ds_read_b128 v[52:55], v158
    ds_read_b64_tr_b16 v[16:17], v139 offset:18432
    ds_read_b64_tr_b16 v[18:19], v139 offset:18688
    v_dot2_f32_bf16 v112, v56, v45, v112
    v_dot2_f32_bf16 v113, v57, v45, v113
    v_dot2_f32_bf16 v114, v58, v45, v114
    v_dot2_f32_bf16 v115, v59, v45, v115
    v_mfma_f32_32x32x16_bf16 v[96:111], v[56:59], v[36:39], v[96:111]
    ds_read_b64_tr_b16 v[20:21], v139 offset:22528
    ds_read_b64_tr_b16 v[22:23], v139 offset:22784
    v_dot2_f32_bf16 v116, v56, v56, v116
    v_dot2_f32_bf16 v117, v57, v57, v117
    v_dot2_f32_bf16 v118, v58, v58, v118
    v_dot2_f32_bf16 v119, v59, v59, v119
    v_mfma_f32_32x32x16_bf16 v[64:79], v[28:31], v[56:59], v[64:79]
    ds_read_b64_tr_b16 v[24:25], v139 offset:26624
    ds_read_b64_tr_b16 v[26:27], v139 offset:26880
    s_cmp_lg_u32 s32, 1
    s_cbranch_scc1 k1_cs13
    v_dot2_f32_bf16 v120, v28, v45, v120
    v_dot2_f32_bf16 v121, v29, v45, v121
    v_dot2_f32_bf16 v122, v30, v45, v122
    v_dot2_f32_bf16 v123, v31, v45, v123
    v_dot2_f32_bf16 v124, v32, v45, v124
    v_dot2_f32_bf16 v125, v33, v45, v125
    v_dot2_f32_bf16 v126, v34, v45, v126
    v_dot2_f32_bf16 v127, v35, v45, v127
    v_dot2_f32_bf16 v128, v36, v45, v128
    v_dot2_f32_bf16 v129, v37, v45, v129
    v_dot2_f32_bf16 v130, v38, v45, v130
    v_dot2_f32_bf16 v131, v39, v45, v131
k1_cs13:
    s_waitcnt lgkmcnt(0)
    v_mfma_f32_32x32x16_bf16 v[80:95], v[52:55], v[20:23], v[80:95]
    ds_read_b128 v[56:59], v159
    ds_read_b64_tr_b16 v[28:29], v139 offset:19456
    ds_read_b64_tr_b16 v[30:31], v139 offset:19712
    v_dot2_f32_bf16 v112, v52, v45, v112
    v_dot2_f32_bf16 v113, v53, v45, v113
    v_dot2_f32_bf16 v114, v54, v45, v114
    v_dot2_f32_bf16 v115, v55, v45, v115
    v_mfma_f32_32x32x16_bf16 v[96:111], v[52:55], v[24:27], v[96:111]
    ds_read_b64_tr_b16 v[32:33], v139 offset:23552
    ds_read_b64_tr_b16 v[34:35], v139 offset:23808
    v_dot2_f32_bf16 v116, v52, v52, v116
    v_dot2_f32_bf16 v117, v53, v53, v117
    v_dot2_f32_bf16 v118, v54, v54, v118
    v_dot2_f32_bf16 v119, v55, v55, v119
    v_mfma_f32_32x32x16_bf16 v[64:79], v[16:19], v[52:55], v[64:79]
    ds_read_b64_tr_b16 v[36:37], v139 offset:27648
    ds_read_b64_tr_b16 v[38:39], v139 offset:27904
    s_cmp_lg_u32 s32, 2
    s_cbranch_scc1 k1_cs14
    v_dot2_f32_bf16 v120, v16, v45, v120
    v_dot2_f32_bf16 v121, v17, v45, v121
    v_dot2_f32_bf16 v122, v18, v45, v122
    v_dot2_f32_bf16 v123, v19, v45, v123
    v_dot2_f32_bf16 v124, v20, v45, v124
    v_dot2_f32_bf16 v125, v21, v45, v125
    v_dot2_f32_bf16 v126, v22, v45, v126
    v_dot2_f32_bf16 v127, v23, v45, v127
    v_dot2_f32_bf16 v128, v24, v45, v128
    v_dot2_f32_bf16 v129, v25, v45, v129
    v_dot2_f32_bf16 v130, v26, v45, v130
    v_dot2_f32_bf16 v131, v27, v45, v131
k1_cs14:
    s_waitcnt lgkmcnt(0)
    s_barrier
    v_mfma_f32_32x32x16_bf16 v[80:95], v[56:59], v[32:35], v[80:95]
    ds_read_b128 v[52:55], v160
    ds_read_b64_tr_b16 v[16:17], v140 offset:16384
    ds_read_b64_tr_b16 v[18:19], v140 offset:16640
    v_dot2_f32_bf16 v112, v56, v45, v112
    v_dot2_f32_bf16 v113, v57, v45, v113
    v_dot2_f32_bf16 v114, v58, v45, v114
    v_dot2_f32_bf16 v115, v59, v45, v115
    v_mfma_f32_32x32x16_bf16 v[96:111], v[56:59], v[36:39], v[96:111]
    ds_read_b64_tr_b16 v[20:21], v140 offset:20480
    ds_read_b64_tr_b16 v[22:23], v140 offset:20736
    v_dot2_f32_bf16 v116, v56, v56, v116
    v_dot2_f32_bf16 v117, v57, v57, v117
    v_dot2_f32_bf16 v118, v58, v58, v118
    v_dot2_f32_bf16 v119, v59, v59, v119
    v_mfma_f32_32x32x16_bf16 v[64:79], v[28:31], v[56:59], v[64:79]
    ds_read_b64_tr_b16 v[24:25], v140 offset:24576
    ds_read_b64_tr_b16 v[26:27], v140 offset:24832
    s_cmp_lg_u32 s32, 3
    s_cbranch_scc1 k1_cs15
    v_dot2_f32_bf16 v120, v28, v45, v120
    v_dot2_f32_bf16 v121, v29, v45, v121
    v_dot2_f32_bf16 v122, v30, v45, v122
    v_dot2_f32_bf16 v123, v31, v45, v123
    v_dot2_f32_bf16 v124, v32, v45, v124
    v_dot2_f32_bf16 v125, v33, v45, v125
    v_dot2_f32_bf16 v126, v34, v45, v126
    v_dot2_f32_bf16 v127, v35, v45, v127
    v_dot2_f32_bf16 v128, v36, v45, v128
    v_dot2_f32_bf16 v129, v37, v45, v129
    v_dot2_f32_bf16 v130, v38, v45, v130
    v_dot2_f32_bf16 v131, v39, v45, v131
k1_cs15:
    s_waitcnt lgkmcnt(0)
    v_mfma_f32_32x32x16_bf16 v[80:95], v[52:55], v[20:23], v[80:95]
    ds_read_b128 v[56:59], v161
    ds_read_b64_tr_b16 v[28:29], v140 offset:17408
    ds_read_b64_tr_b16 v[30:31], v140 offset:17664
    v_dot2_f32_bf16 v112, v52, v45, v112
    v_dot2_f32_bf16 v113, v53, v45, v113
    v_dot2_f32_bf16 v114, v54, v45, v114
    v_dot2_f32_bf16 v115, v55, v45, v115
    v_mfma_f32_32x32x16_bf16 v[96:111], v[52:55], v[24:27], v[96:111]
    ds_read_b64_tr_b16 v[32:33], v140 offset:21504
    ds_read_b64_tr_b16 v[34:35], v140 offset:21760
    v_dot2_f32_bf16 v116, v52, v52, v116
    v_dot2_f32_bf16 v117, v53, v53, v117
    v_dot2_f32_bf16 v118, v54, v54, v118
    v_dot2_f32_bf16 v119, v55, v55, v119
    v_mfma_f32_32x32x16_bf16 v[64:79], v[16:19], v[52:55], v[64:79]
    ds_read_b64_tr_b16 v[36:37], v140 offset:25600
    ds_read_b64_tr_b16 v[38:39], v140 offset:25856
    s_cmp_lg_u32 s32, 0
    s_cbranch_scc1 k1_cs16
    v_dot2_f32_bf16 v120, v16, v45, v120
    v_dot2_f32_bf16 v121, v17, v45, v121
    v_dot2_f32_bf16 v122, v18, v45, v122
    v_dot2_f32_bf16 v123, v19, v45, v123
    v_dot2_f32_bf16 v124, v20, v45, v124
    v_dot2_f32_bf16 v125, v21, v45, v125
    v_dot2_f32_bf16 v126, v22, v45, v126
    v_dot2_f32_bf16 v127, v23, v45, v127
    v_dot2_f32_bf16 v128, v24, v45, v128
    v_dot2_f32_bf16 v129, v25, v45, v129
    v_dot2_f32_bf16 v130, v26, v45, v130
    v_dot2_f32_bf16 v131, v27, v45, v131
k1_cs16:
    s_waitcnt lgkmcnt(0)
    v_mfma_f32_32x32x16_bf16 v[80:95], v[56:59], v[32:35], v[80:95]
    ds_read_b128 v[52:55], v162
    ds_read_b64_tr_b16 v[16:17], v140 offset:18432
    ds_read_b64_tr_b16 v[18:19], v140 offset:18688
    v_dot2_f32_bf16 v112, v56, v45, v112
    v_dot2_f32_bf16 v113, v57, v45, v113
    v_dot2_f32_bf16 v114, v58, v45, v114
    v_dot2_f32_bf16 v115, v59, v45, v115
    v_mfma_f32_32x32x16_bf16 v[96:111], v[56:59], v[36:39], v[96:111]
    ds_read_b64_tr_b16 v[20:21], v140 offset:22528
    ds_read_b64_tr_b16 v[22:23], v140 offset:22784
    v_dot2_f32_bf16 v116, v56, v56, v116
    v_dot2_f32_bf16 v117, v57, v57, v117
    v_dot2_f32_bf16 v118, v58, v58, v118
    v_dot2_f32_bf16 v119, v59, v59, v119
    v_mfma_f32_32x32x16_bf16 v[64:79], v[28:31], v[56:59], v[64:79]
    ds_read_b64_tr_b16 v[24:25], v140 offset:26624
    ds_read_b64_tr_b16 v[26:27], v140 offset:26880
    s_cmp_lg_u32 s32, 1
    s_cbranch_scc1 k1_cs17
    v_dot2_f32_bf16 v120, v28, v45, v120
    v_dot2_f32_bf16 v121, v29, v45, v121
    v_dot2_f32_bf16 v122, v30, v45, v122
    v_dot2_f32_bf16 v123, v31, v45, v123
    v_dot2_f32_bf16 v124, v32, v45, v124
    v_dot2_f32_bf16 v125, v33, v45, v125
    v_dot2_f32_bf16 v126, v34, v45, v126
    v_dot2_f32_bf16 v127, v35, v45, v127
    v_dot2_f32_bf16 v128, v36, v45, v128
    v_dot2_f32_bf16 v129, v37, v45, v129
    v_dot2_f32_bf16 v130, v38, v45, v130
    v_dot2_f32_bf16 v131, v39, v45, v131
k1_cs17:
    s_waitcnt lgkmcnt(0)
    v_mfma_f32_32x32x16_bf16 v[80:95], v[52:55], v[20:23], v[80:95]
    ds_read_b128 v[56:59], v163
    ds_read_b64_tr_b16 v[28:29], v140 offset:19456
    ds_read_b64_tr_b16 v[30:31], v140 offset:19712
    v_dot2_f32_bf16 v112, v52, v45, v112
    v_dot2_f32_bf16 v113, v53, v45, v113
    v_dot2_f32_bf16 v114, v54, v45, v114
    v_dot2_f32_bf16 v115, v55, v45, v115
    v_mfma_f32_32x32x16_bf16 v[96:111], v[52:55], v[24:27], v[96:111]
    ds_read_b64_tr_b16 v[32:33], v140 offset:23552
    ds_read_b64_tr_b16 v[34:35], v140 offset:23808
    v_dot2_f32_bf16 v116, v52, v52, v116
    v_dot2_f32_bf16 v117, v53, v53, v117
    v_dot2_f32_bf16 v118, v54, v54, v118
    v_dot2_f32_bf16 v119, v55, v55, v119
    v_mfma_f32_32x32x16_bf16 v[64:79], v[16:19], v[52:55], v[64:79]
    ds_read_b64_tr_b16 v[36:37], v140 offset:27648
    ds_read_b64_tr_b16 v[38:39], v140 offset:27904
    s_cmp_lg_u32 s32, 2
    s_cbranch_scc1 k1_cs18
    v_dot2_f32_bf16 v120, v16, v45, v120
    v_dot2_f32_bf16 v121, v17, v45, v121
    v_dot2_f32_bf16 v122, v18, v45, v122
    v_dot2_f32_bf16 v123, v19, v45, v123
    v_dot2_f32_bf16 v124, v20, v45, v124
    v_dot2_f32_bf16 v125, v21, v45, v125
    v_dot2_f32_bf16 v126, v22, v45, v126
    v_dot2_f32_bf16 v127, v23, v45, v127
    v_dot2_f32_bf16 v128, v24, v45, v128
    v_dot2_f32_bf16 v129, v25, v45, v129
    v_dot2_f32_bf16 v130, v26, v45, v130
    v_dot2_f32_bf16 v131, v27, v45, v131
k1_cs18:
    s_waitcnt lgkmcnt(0)
    s_barrier
    v_mfma_f32_32x32x16_bf16 v[80:95], v[56:59], v[32:35], v[80:95]
    ds_read_b128 v[52:55], v144
    ds_read_b64_tr_b16 v[16:17], v136 offset:16384
    ds_read_b64_tr_b16 v[18:19], v136 offset:16640
    v_dot2_f32_bf16 v112, v56, v45, v112
    v_dot2_f32_bf16 v113, v57, v45, v113
    v_dot2_f32_bf16 v114, v58, v45, v114
    v_dot2_f32_bf16 v115, v59, v45, v115
    v_mfma_f32_32x32x16_bf16 v[96:111], v[56:59], v[36:39], v[96:111]
    ds_read_b64_tr_b16 v[20:21], v136 offset:20480
    ds_read_b64_tr_b16 v[22:23], v136 offset:20736
    v_dot2_f32_bf16 v116, v56, v56, v116
    v_dot2_f32_bf16 v117, v57, v57, v117
    v_dot2_f32_bf16 v118, v58, v58, v118
    v_dot2_f32_bf16 v119, v59, v59, v119
    v_mfma_f32_32x32x16_bf16 v[64:79], v[28:31], v[56:59], v[64:79]
    ds_read_b64_tr_b16 v[24:25], v136 offset:24576
    ds_read_b64_tr_b16 v[26:27], v136 offset:24832
    s_cmp_lg_u32 s32, 3
    s_cbranch_scc1 k1_cs19
    v_dot2_f32_bf16 v120, v28, v45, v120
    v_dot2_f32_bf16 v121, v29, v45, v121
    v_dot2_f32_bf16 v122, v30, v45, v122
    v_dot2_f32_bf16 v123, v31, v45, v123
    v_dot2_f32_bf16 v124, v32, v45, v124
    v_dot2_f32_bf16 v125, v33, v45, v125
    v_dot2_f32_bf16 v126, v34, v45, v126
    v_dot2_f32_bf16 v127, v35, v45, v127
    v_dot2_f32_bf16 v128, v36, v45, v128
    v_dot2_f32_bf16 v129, v37, v45, v129
    v_dot2_f32_bf16 v130, v38, v45, v130
    v_dot2_f32_bf16 v131, v39, v45, v131
k1_cs19:
    s_waitcnt lgkmcnt(0)
    v_mfma_f32_32x32x16_bf16 v[80:95], v[52:55], v[20:23], v[80:95]
    ds_read_b128 v[56:59], v145
    ds_read_b64_tr_b16 v[28:29], v136 offset:17408
    ds_read_b64_tr_b16 v[30:31], v136 offset:17664
    v_dot2_f32_bf16 v112, v52, v45, v112
    v_dot2_f32_bf16 v113, v53, v45, v113
    v_dot2_f32_bf16 v114, v54, v45, v114
    v_dot2_f32_bf16 v115, v55, v45, v115
    v_mfma_f32_32x32x16_bf16 v[96:111], v[52:55], v[24:27], v[96:111]
    ds_read_b64_tr_b16 v[32:33], v136 offset:21504
    ds_read_b64_tr_b16 v[34:35], v136 offset:21760
    v_dot2_f32_bf16 v116, v52, v52, v116
    v_dot2_f32_bf16 v117, v53, v53, v117
    v_dot2_f32_bf16 v118, v54, v54, v118
    v_dot2_f32_bf16 v119, v55, v55, v119
    v_mfma_f32_32x32x16_bf16 v[64:79], v[16:19], v[52:55], v[64:79]
    ds_read_b64_tr_b16 v[36:37], v136 offset:25600
    ds_read_b64_tr_b16 v[38:39], v136 offset:25856
    s_cmp_lg_u32 s32, 0
    s_cbranch_scc1 k1_cs20
    v_dot2_f32_bf16 v120, v16, v45, v120
    v_dot2_f32_bf16 v121, v17, v45, v121
    v_dot2_f32_bf16 v122, v18, v45, v122
    v_dot2_f32_bf16 v123, v19, v45, v123
    v_dot2_f32_bf16 v124, v20, v45, v124
    v_dot2_f32_bf16 v125, v21, v45, v125
    v_dot2_f32_bf16 v126, v22, v45, v126
    v_dot2_f32_bf16 v127, v23, v45, v127
    v_dot2_f32_bf16 v128, v24, v45, v128
    v_dot2_f32_bf16 v129, v25, v45, v129
    v_dot2_f32_bf16 v130, v26, v45, v130
    v_dot2_f32_bf16 v131, v27, v45, v131
k1_cs20:
    s_waitcnt lgkmcnt(0)
    v_mfma_f32_32x32x16_bf16 v[80:95], v[56:59], v[32:35], v[80:95]
    ds_read_b128 v[52:55], v146
    ds_read_b64_tr_b16 v[16:17], v136 offset:18432
    ds_read_b64_tr_b16 v[18:19], v136 offset:18688
    v_dot2_f32_bf16 v112, v56, v45, v112
    v_dot2_f32_bf16 v113, v57, v45, v113
    v_dot2_f32_bf16 v114, v58, v45, v114
    v_dot2_f32_bf16 v115, v59, v45, v115
    v_mfma_f32_32x32x16_bf16 v[96:111], v[56:59], v[36:39], v[96:111]
    ds_read_b64_tr_b16 v[20:21], v136 offset:22528
    ds_read_b64_tr_b16 v[22:23], v136 offset:22784
    v_dot2_f32_bf16 v116, v56, v56, v116
    v_dot2_f32_bf16 v117, v57, v57, v117
    v_dot2_f32_bf16 v118, v58, v58, v118
    v_dot2_f32_bf16 v119, v59, v59, v119
    v_mfma_f32_32x32x16_bf16 v[64:79], v[28:31], v[56:59], v[64:79]
    ds_read_b64_tr_b16 v[24:25], v136 offset:26624
    ds_read_b64_tr_b16 v[26:27], v136 offset:26880
    s_cmp_lg_u32 s32, 1
    s_cbranch_scc1 k1_cs21
    v_dot2_f32_bf16 v120, v28, v45, v120
    v_dot2_f32_bf16 v121, v29, v45, v121
    v_dot2_f32_bf16 v122, v30, v45, v122
    v_dot2_f32_bf16 v123, v31, v45, v123
    v_dot2_f32_bf16 v124, v32, v45, v124
    v_dot2_f32_bf16 v125, v33, v45, v125
    v_dot2_f32_bf16 v126, v34, v45, v126
    v_dot2_f32_bf16 v127, v35, v45, v127
    v_dot2_f32_bf16 v128, v36, v45, v128
    v_dot2_f32_bf16 v129, v37, v45, v129
    v_dot2_f32_bf16 v130, v38, v45, v130
    v_dot2_f32_bf16 v131, v39, v45, v131
k1_cs21:
    s_waitcnt lgkmcnt(0)
    v_mfma_f32_32x32x16_bf16 v[80:95], v[52:55], v[20:23], v[80:95]
    ds_read_b128 v[56:59], v147
    ds_read_b64_tr_b16 v[28:29], v136 offset:19456
    ds_read_b64_tr_b16 v[30:31], v136 offset:19712
    v_dot2_f32_bf16 v112, v52, v45, v112
    v_dot2_f32_bf16 v113, v53, v45, v113
    v_dot2_f32_bf16 v114, v54, v45, v114
    v_dot2_f32_bf16 v115, v55, v45, v115
    v_mfma_f32_32x32x16_bf16 v[96:111], v[52:55], v[24:27], v[96:111]
    ds_read_b64_tr_b16 v[32:33], v136 offset:23552
    ds_read_b64_tr_b16 v[34:35], v136 offset:23808
    v_dot2_f32_bf16 v116, v52, v52, v116
    v_dot2_f32_bf16 v117, v53, v53, v117
    v_dot2_f32_bf16 v118, v54, v54, v118
    v_dot2_f32_bf16 v119, v55, v55, v119
    v_mfma_f32_32x32x16_bf16 v[64:79], v[16:19], v[52:55], v[64:79]
    ds_read_b64_tr_b16 v[36:37], v136 offset:27648
    ds_read_b64_tr_b16 v[38:39], v136 offset:27904
    s_cmp_lg_u32 s32, 2
    s_cbranch_scc1 k1_cs22
    v_dot2_f32_bf16 v120, v16, v45, v120
    v_dot2_f32_bf16 v121, v17, v45, v121
    v_dot2_f32_bf16 v122, v18, v45, v122
    v_dot2_f32_bf16 v123, v19, v45, v123
    v_dot2_f32_bf16 v124, v20, v45, v124
    v_dot2_f32_bf16 v125, v21, v45, v125
    v_dot2_f32_bf16 v126, v22, v45, v126
    v_dot2_f32_bf16 v127, v23, v45, v127
    v_dot2_f32_bf16 v128, v24, v45, v128
    v_dot2_f32_bf16 v129, v25, v45, v129
    v_dot2_f32_bf16 v130, v26, v45, v130
    v_dot2_f32_bf16 v131, v27, v45, v131
k1_cs22:
    s_waitcnt lgkmcnt(0)
    s_barrier
    v_mfma_f32_32x32x16_bf16 v[80:95], v[56:59], v[32:35], v[80:95]
    ds_read_b128 v[52:55], v148
    ds_read_b64_tr_b16 v[16:17], v137 offset:16384
    ds_read_b64_tr_b16 v[18:19], v137 offset:16640
    v_dot2_f32_bf16 v112, v56, v45, v112
    v_dot2_f32_bf16 v113, v57, v45, v113
    v_dot2_f32_bf16 v114, v58, v45, v114
    v_dot2_f32_bf16 v115, v59, v45, v115
    v_mfma_f32_32x32x16_bf16 v[96:111], v[56:59], v[36:39], v[96:111]
    ds_read_b64_tr_b16 v[20:21], v137 offset:20480
    ds_read_b64_tr_b16 v[22:23], v137 offset:20736
    v_dot2_f32_bf16 v116, v56, v56, v116
    v_dot2_f32_bf16 v117, v57, v57, v117
    v_dot2_f32_bf16 v118, v58, v58, v118
    v_dot2_f32_bf16 v119, v59, v59, v119
    v_mfma_f32_32x32x16_bf16 v[64:79], v[28:31], v[56:59], v[64:79]
    ds_read_b64_tr_b16 v[24:25], v137 offset:24576
    ds_read_b64_tr_b16 v[26:27], v137 offset:24832
    s_cmp_lg_u32 s32, 3
    s_cbranch_scc1 k1_cs23
    v_dot2_f32_bf16 v120, v28, v45, v120
    v_dot2_f32_bf16 v121, v29, v45, v121
    v_dot2_f32_bf16 v122, v30, v45, v122
    v_dot2_f32_bf16 v123, v31, v45, v123
    v_dot2_f32_bf16 v124, v32, v45, v124
    v_dot2_f32_bf16 v125, v33, v45, v125
    v_dot2_f32_bf16 v126, v34, v45, v126
    v_dot2_f32_bf16 v127, v35, v45, v127
    v_dot2_f32_bf16 v128, v36, v45, v128
    v_dot2_f32_bf16 v129, v37, v45, v129
    v_dot2_f32_bf16 v130, v38, v45, v130
    v_dot2_f32_bf16 v131, v39, v45, v131
k1_cs23:
    s_waitcnt lgkmcnt(0)
    v_mfma_f32_32x32x16_bf16 v[80:95], v[52:55], v[20:23], v[80:95]
    ds_read_b128 v[56:59], v149
    ds_read_b64_tr_b16 v[28:29], v137 offset:17408
    ds_read_b64_tr_b16 v[30:31], v137 offset:17664
    v_dot2_f32_bf16 v112, v52, v45, v112
    v_dot2_f32_bf16 v113, v53, v45, v113
    v_dot2_f32_bf16 v114, v54, v45, v114
    v_dot2_f32_bf16 v115, v55, v45, v115
    v_mfma_f32_32x32x16_bf16 v[96:111], v[52:55], v[24:27], v[96:111]
    ds_read_b64_tr_b16 v[32:33], v137 offset:21504
    ds_read_b64_tr_b16 v[34:35], v137 offset:21760
    v_dot2_f32_bf16 v116, v52, v52, v116
    v_dot2_f32_bf16 v117, v53, v53, v117
    v_dot2_f32_bf16 v118, v54, v54, v118
    v_dot2_f32_bf16 v119, v55, v55, v119
    v_mfma_f32_32x32x16_bf16 v[64:79], v[16:19], v[52:55], v[64:79]
    ds_read_b64_tr_b16 v[36:37], v137 offset:25600
    ds_read_b64_tr_b16 v[38:39], v137 offset:25856
    s_cmp_lg_u32 s32, 0
    s_cbranch_scc1 k1_cs24
    v_dot2_f32_bf16 v120, v16, v45, v120
    v_dot2_f32_bf16 v121, v17, v45, v121
    v_dot2_f32_bf16 v122, v18, v45, v122
    v_dot2_f32_bf16 v123, v19, v45, v123
    v_dot2_f32_bf16 v124, v20, v45, v124
    v_dot2_f32_bf16 v125, v21, v45, v125
    v_dot2_f32_bf16 v126, v22, v45, v126
    v_dot2_f32_bf16 v127, v23, v45, v127
    v_dot2_f32_bf16 v128, v24, v45, v128
    v_dot2_f32_bf16 v129, v25, v45, v129
    v_dot2_f32_bf16 v130, v26, v45, v130
    v_dot2_f32_bf16 v131, v27, v45, v131
k1_cs24:
    s_waitcnt lgkmcnt(0)
    v_mfma_f32_32x32x16_bf16 v[80:95], v[56:59], v[32:35], v[80:95]
    ds_read_b128 v[52:55], v150
    ds_read_b64_tr_b16 v[16:17], v137 offset:18432
    ds_read_b64_tr_b16 v[18:19], v137 offset:18688
    v_dot2_f32_bf16 v112, v56, v45, v112
    v_dot2_f32_bf16 v113, v57, v45, v113
    v_dot2_f32_bf16 v114, v58, v45, v114
    v_dot2_f32_bf16 v115, v59, v45, v115
    v_mfma_f32_32x32x16_bf16 v[96:111], v[56:59], v[36:39], v[96:111]
    ds_read_b64_tr_b16 v[20:21], v137 offset:22528
    ds_read_b64_tr_b16 v[22:23], v137 offset:22784
    v_dot2_f32_bf16 v116, v56, v56, v116
    v_dot2_f32_bf16 v117, v57, v57, v117
    v_dot2_f32_bf16 v118, v58, v58, v118
    v_dot2_f32_bf16 v119, v59, v59, v119
    v_mfma_f32_32x32x16_bf16 v[64:79], v[28:31], v[56:59], v[64:79]
    ds_read_b64_tr_b16 v[24:25], v137 offset:26624
    ds_read_b64_tr_b16 v[26:27], v137 offset:26880
    s_cmp_lg_u32 s32, 1
    s_cbranch_scc1 k1_cs25
    v_dot2_f32_bf16 v120, v28, v45, v120
    v_dot2_f32_bf16 v121, v29, v45, v121
    v_dot2_f32_bf16 v122, v30, v45, v122
    v_dot2_f32_bf16 v123, v31, v45, v123
    v_dot2_f32_bf16 v124, v32, v45, v124
    v_dot2_f32_bf16 v125, v33, v45, v125
    v_dot2_f32_bf16 v126, v34, v45, v126
    v_dot2_f32_bf16 v127, v35, v45, v127
    v_dot2_f32_bf16 v128, v36, v45, v128
    v_dot2_f32_bf16 v129, v37, v45, v129
    v_dot2_f32_bf16 v130, v38, v45, v130
    v_dot2_f32_bf16 v131, v39, v45, v131
k1_cs25:
    s_waitcnt lgkmcnt(0)
    v_mfma_f32_32x32x16_bf16 v[80:95], v[52:55], v[20:23], v[80:95]
    ds_read_b128 v[56:59], v151
    ds_read_b64_tr_b16 v[28:29], v137 offset:19456
    ds_read_b64_tr_b16 v[30:31], v137 offset:19712
    v_dot2_f32_bf16 v112, v52, v45, v112
    v_dot2_f32_bf16 v113, v53, v45, v113
    v_dot2_f32_bf16 v114, v54, v45, v114
    v_dot2_f32_bf16 v115, v55, v45, v115
    v_mfma_f32_32x32x16_bf16 v[96:111], v[52:55], v[24:27], v[96:111]
    ds_read_b64_tr_b16 v[32:33], v137 offset:23552
    ds_read_b64_tr_b16 v[34:35], v137 offset:23808
    v_dot2_f32_bf16 v116, v52, v52, v116
    v_dot2_f32_bf16 v117, v53, v53, v117
    v_dot2_f32_bf16 v118, v54, v54, v118
    v_dot2_f32_bf16 v119, v55, v55, v119
    v_mfma_f32_32x32x16_bf16 v[64:79], v[16:19], v[52:55], v[64:79]
    ds_read_b64_tr_b16 v[36:37], v137 offset:27648
    ds_read_b64_tr_b16 v[38:39], v137 offset:27904
    s_cmp_lg_u32 s32, 2
    s_cbranch_scc1 k1_cs26
    v_dot2_f32_bf16 v120, v16, v45, v120
    v_dot2_f32_bf16 v121, v17, v45, v121
    v_dot2_f32_bf16 v122, v18, v45, v122
    v_dot2_f32_bf16 v123, v19, v45, v123
    v_dot2_f32_bf16 v124, v20, v45, v124
    v_dot2_f32_bf16 v125, v21, v45, v125
    v_dot2_f32_bf16 v126, v22, v45, v126
    v_dot2_f32_bf16 v127, v23, v45, v127
    v_dot2_f32_bf16 v128, v24, v45, v128
    v_dot2_f32_bf16 v129, v25, v45, v129
    v_dot2_f32_bf16 v130, v26, v45, v130
    v_dot2_f32_bf16 v131, v27, v45, v131
k1_cs26:
    s_waitcnt lgkmcnt(0)
    s_barrier
    v_mfma_f32_32x32x16_bf16 v[80:95], v[56:59], v[32:35], v[80:95]
    ds_read_b128 v[52:55], v152
    ds_read_b64_tr_b16 v[16:17], v138 offset:16384
    ds_read_b64_tr_b16 v[18:19], v138 offset:16640
    v_dot2_f32_bf16 v112, v56, v45, v112
    v_dot2_f32_bf16 v113, v57, v45, v113
    v_dot2_f32_bf16 v114, v58, v45, v114
    v_dot2_f32_bf16 v115, v59, v45, v115
    v_mfma_f32_32x32x16_bf16 v[96:111], v[56:59], v[36:39], v[96:111]
    ds_read_b64_tr_b16 v[20:21], v138 offset:20480
    ds_read_b64_tr_b16 v[22:23], v138 offset:20736
    v_dot2_f32_bf16 v116, v56, v56, v116
    v_dot2_f32_bf16 v117, v57, v57, v117
    v_dot2_f32_bf16 v118, v58, v58, v118
    v_dot2_f32_bf16 v119, v59, v59, v119
    v_mfma_f32_32x32x16_bf16 v[64:79], v[28:31], v[56:59], v[64:79]
    ds_read_b64_tr_b16 v[24:25], v138 offset:24576
    ds_read_b64_tr_b16 v[26:27], v138 offset:24832
    s_cmp_lg_u32 s32, 3
    s_cbranch_scc1 k1_cs27
    v_dot2_f32_bf16 v120, v28, v45, v120
    v_dot2_f32_bf16 v121, v29, v45, v121
    v_dot2_f32_bf16 v122, v30, v45, v122
    v_dot2_f32_bf16 v123, v31, v45, v123
    v_dot2_f32_bf16 v124, v32, v45, v124
    v_dot2_f32_bf16 v125, v33, v45, v125
    v_dot2_f32_bf16 v126, v34, v45, v126
    v_dot2_f32_bf16 v127, v35, v45, v127
    v_dot2_f32_bf16 v128, v36, v45, v128
    v_dot2_f32_bf16 v129, v37, v45, v129
    v_dot2_f32_bf16 v130, v38, v45, v130
    v_dot2_f32_bf16 v131, v39, v45, v131
k1_cs27:
    s_waitcnt lgkmcnt(0)
    v_mfma_f32_32x32x16_bf16 v[80:95], v[52:55], v[20:23], v[80:95]
    ds_read_b128 v[56:59], v153
    ds_read_b64_tr_b16 v[28:29], v138 offset:17408
    ds_read_b64_tr_b16 v[30:31], v138 offset:17664
    v_dot2_f32_bf16 v112, v52, v45, v112
    v_dot2_f32_bf16 v113, v53, v45, v113
    v_dot2_f32_bf16 v114, v54, v45, v114
    v_dot2_f32_bf16 v115, v55, v45, v115
    v_mfma_f32_32x32x16_bf16 v[96:111], v[52:55], v[24:27], v[96:111]
    ds_read_b64_tr_b16 v[32:33], v138 offset:21504
    ds_read_b64_tr_b16 v[34:35], v138 offset:21760
    v_dot2_f32_bf16 v116, v52, v52, v116
    v_dot2_f32_bf16 v117, v53, v53, v117
    v_dot2_f32_bf16 v118, v54, v54, v118
    v_dot2_f32_bf16 v119, v55, v55, v119
    v_mfma_f32_32x32x16_bf16 v[64:79], v[16:19], v[52:55], v[64:79]
    ds_read_b64_tr_b16 v[36:37], v138 offset:25600
    ds_read_b64_tr_b16 v[38:39], v138 offset:25856
    s_cmp_lg_u32 s32, 0
    s_cbranch_scc1 k1_cs28
    v_dot2_f32_bf16 v120, v16, v45, v120
    v_dot2_f32_bf16 v121, v17, v45, v121
    v_dot2_f32_bf16 v122, v18, v45, v122
    v_dot2_f32_bf16 v123, v19, v45, v123
    v_dot2_f32_bf16 v124, v20, v45, v124
    v_dot2_f32_bf16 v125, v21, v45, v125
    v_dot2_f32_bf16 v126, v22, v45, v126
    v_dot2_f32_bf16 v127, v23, v45, v127
    v_dot2_f32_bf16 v128, v24, v45, v128
    v_dot2_f32_bf16 v129, v25, v45, v129
    v_dot2_f32_bf16 v130, v26, v45, v130
    v_dot2_f32_bf16 v131, v27, v45, v131
k1_cs28:
    s_waitcnt lgkmcnt(0)
    v_mfma_f32_32x32x16_bf16 v[80:95], v[56:59], v[32:35], v[80:95]
    ds_read_b128 v[52:55], v154
    ds_read_b64_tr_b16 v[16:17], v138 offset:18432
    ds_read_b64_tr_b16 v[18:19], v138 offset:18688
    v_dot2_f32_bf16 v112, v56, v45, v112
    v_dot2_f32_bf16 v113, v57, v45, v113
    v_dot2_f32_bf16 v114, v58, v45, v114
    v_dot2_f32_bf16 v115, v59, v45, v115
    v_mfma_f32_32x32x16_bf16 v[96:111], v[56:59], v[36:39], v[96:111]
    ds_read_b64_tr_b16 v[20:21], v138 offset:22528
    ds_read_b64_tr_b16 v[22:23], v138 offset:22784
    v_dot2_f32_bf16 v116, v56, v56, v116
    v_dot2_f32_bf16 v117, v57, v57, v117
    v_dot2_f32_bf16 v118, v58, v58, v118
    v_dot2_f32_bf16 v119, v59, v59, v119
    v_mfma_f32_32x32x16_bf16 v[64:79], v[28:31], v[56:59], v[64:79]
    ds_read_b64_tr_b16 v[24:25], v138 offset:26624
    ds_read_b64_tr_b16 v[26:27], v138 offset:26880
    s_cmp_lg_u32 s32, 1
    s_cbranch_scc1 k1_cs29
    v_dot2_f32_bf16 v120, v28, v45, v120
    v_dot2_f32_bf16 v121, v29, v45, v121
    v_dot2_f32_bf16 v122, v30, v45, v122
    v_dot2_f32_bf16 v123, v31, v45, v123
    v_dot2_f32_bf16 v124, v32, v45, v124
    v_dot2_f32_bf16 v125, v33, v45, v125
    v_dot2_f32_bf16 v126, v34, v45, v126
    v_dot2_f32_bf16 v127, v35, v45, v127
    v_dot2_f32_bf16 v128, v36, v45, v128
    v_dot2_f32_bf16 v129, v37, v45, v129
    v_dot2_f32_bf16 v130, v38, v45, v130
    v_dot2_f32_bf16 v131, v39, v45, v131
k1_cs29:
    s_waitcnt lgkmcnt(0)
    v_mfma_f32_32x32x16_bf16 v[80:95], v[52:55], v[20:23], v[80:95]
    ds_read_b128 v[56:59], v155
    ds_read_b64_tr_b16 v[28:29], v138 offset:19456
    ds_read_b64_tr_b16 v[30:31], v138 offset:19712
    v_dot2_f32_bf16 v112, v52, v45, v112
    v_dot2_f32_bf16 v113, v53, v45, v113
    v_dot2_f32_bf16 v114, v54, v45, v114
    v_dot2_f32_bf16 v115, v55, v45, v115
    v_mfma_f32_32x32x16_bf16 v[96:111], v[52:55], v[24:27], v[96:111]
    ds_read_b64_tr_b16 v[32:33], v138 offset:23552
    ds_read_b64_tr_b16 v[34:35], v138 offset:23808
    v_dot2_f32_bf16 v116, v52, v52, v116
    v_dot2_f32_bf16 v117, v53, v53, v117
    v_dot2_f32_bf16 v118, v54, v54, v118
    v_dot2_f32_bf16 v119, v55, v55, v119
    v_mfma_f32_32x32x16_bf16 v[64:79], v[16:19], v[52:55], v[64:79]
    ds_read_b64_tr_b16 v[36:37], v138 offset:27648
    ds_read_b64_tr_b16 v[38:39], v138 offset:27904
    s_cmp_lg_u32 s32, 2
    s_cbranch_scc1 k1_cs30
    v_dot2_f32_bf16 v120, v16, v45, v120
    v_dot2_f32_bf16 v121, v17, v45, v121
    v_dot2_f32_bf16 v122, v18, v45, v122
    v_dot2_f32_bf16 v123, v19, v45, v123
    v_dot2_f32_bf16 v124, v20, v45, v124
    v_dot2_f32_bf16 v125, v21, v45, v125
    v_dot2_f32_bf16 v126, v22, v45, v126
    v_dot2_f32_bf16 v127, v23, v45, v127
    v_dot2_f32_bf16 v128, v24, v45, v128
    v_dot2_f32_bf16 v129, v25, v45, v129
    v_dot2_f32_bf16 v130, v26, v45, v130
    v_dot2_f32_bf16 v131, v27, v45, v131
k1_cs30:
    s_waitcnt lgkmcnt(0)
    v_mfma_f32_32x32x16_bf16 v[80:95], v[56:59], v[32:35], v[80:95]
    v_dot2_f32_bf16 v112, v56, v45, v112
    v_dot2_f32_bf16 v113, v57, v45, v113
    v_dot2_f32_bf16 v114, v58, v45, v114
    v_dot2_f32_bf16 v115, v59, v45, v115
    v_mfma_f32_32x32x16_bf16 v[96:111], v[56:59], v[36:39], v[96:111]
    v_dot2_f32_bf16 v116, v56, v56, v116
    v_dot2_f32_bf16 v117, v57, v57, v117
    v_dot2_f32_bf16 v118, v58, v58, v118
    v_dot2_f32_bf16 v119, v59, v59, v119
    v_mfma_f32_32x32x16_bf16 v[64:79], v[28:31], v[56:59], v[64:79]
    s_cmp_lg_u32 s32, 3
    s_cbranch_scc1 k1_cs31
    v_dot2_f32_bf16 v120, v28, v45, v120
    v_dot2_f32_bf16 v121, v29, v45, v121
    v_dot2_f32_bf16 v122, v30, v45, v122
    v_dot2_f32_bf16 v123, v31, v45, v123
    v_dot2_f32_bf16 v124, v32, v45, v124
    v_dot2_f32_bf16 v125, v33, v45, v125
    v_dot2_f32_bf16 v126, v34, v45, v126
    v_dot2_f32_bf16 v127, v35, v45, v127
    v_dot2_f32_bf16 v128, v36, v45, v128
    v_dot2_f32_bf16 v129, v37, v45, v129
    v_dot2_f32_bf16 v130, v38, v45, v130
    v_dot2_f32_bf16 v131, v39, v45, v131
k1_cs31:
    s_nop 3
    v_add_f32 v112, v112, v113
    v_add_f32 v114, v114, v115
    v_add_f32 v40, v112, v114
    v_add_f32 v116, v116, v117
    v_add_f32 v118, v118, v119
    v_add_f32 v41, v116, v118
    v_add_f32 v120, v120, v121
    v_add_f32 v122, v122, v123
    v_add_f32 v42, v120, v122
    v_add_f32 v124, v124, v125
    v_add_f32 v126, v126, v127
    v_add_f32 v43, v124, v126
    v_add_f32 v128, v128, v129
    v_add_f32 v130, v130, v131
    v_add_f32 v44, v128, v130
    v_mov_b32 v8, v40
    s_nop 1
    v_permlane32_swap_b32 v40, v8
    s_nop 0
    v_add_f32 v40, v40, v8
    v_mov_b32 v8, v41
    s_nop 1
    v_permlane32_swap_b32 v41, v8
    s_nop 0
    v_add_f32 v41, v41, v8
    v_mov_b32 v8, v42
    s_nop 1
    v_permlane32_swap_b32 v42, v8
    s_nop 0
    v_add_f32 v42, v42, v8
    v_mov_b32 v8, v43
    s_nop 1
    v_permlane32_swap_b32 v43, v8
    s_nop 0
    v_add_f32 v43, v43, v8
    v_mov_b32 v8, v44
    s_nop 1
    v_permlane32_swap_b32 v44, v8
    s_nop 0
    v_add_f32 v44, v44, v8
    s_mul_i32 s38, s32, 384
    s_add_u32 s38, s38, 88064
    v_lshlrev_b32 v11, 2, v2
    v_add_u32 v12, s38, v11
    ds_write_b32 v12, v42
    ds_write_b32 v12, v43 offset:128
    ds_write_b32 v12, v44 offset:256
    v_mul_f32 v40, 0x3b000000, v40
    v_mul_f32 v41, 0x3b000000, v41
    v_fma_f32 v41, -v40, v40, v41
    v_max_f32 v41, 0, v41
    v_add_f32 v41, 0x3727c5ac, v41
    v_rsq_f32 v9, v41
    s_nop 0
    v_mul_f32 v10, v40, v9
    v_sub_f32 v10, 0, v10
    s_lshl_b32 s38, s32, 9
    s_add_u32 s38, s38, 86016
    v_add_u32 v12, s38, v11
    ds_write_b32 v12, v9
    ds_write_b32 v12, v10 offset:128
    v_add_u32 v13, 88064, v11
    s_waitcnt lgkmcnt(0)
    s_barrier
    ds_read_b32 v42, v13 offset:0
    ds_read_b32 v43, v13 offset:128
    ds_read_b32 v44, v13 offset:256
    ds_read_b32 v176, v13 offset:384
    ds_read_b32 v177, v13 offset:512
    ds_read_b32 v178, v13 offset:640
    ds_read_b32 v179, v13 offset:768
    ds_read_b32 v180, v13 offset:896
    ds_read_b32 v181, v13 offset:1024
    ds_read_b32 v182, v13 offset:1152
    ds_read_b32 v183, v13 offset:1280
    ds_read_b32 v184, v13 offset:1408
    v_lshlrev_b32 v14, 4, v3
    v_add_u32 v14, s38, v14
    ds_read_b128 v[112:115], v14 offset:0
    ds_read_b128 v[128:131], v14 offset:128
    ds_read_b128 v[116:119], v14 offset:32
    ds_read_b128 v[132:135], v14 offset:160
    ds_read_b128 v[120:123], v14 offset:64
    ds_read_b128 v[136:139], v14 offset:192
    ds_read_b128 v[124:127], v14 offset:96
    ds_read_b128 v[140:143], v14 offset:224
    s_waitcnt lgkmcnt(0)
    v_add_f32 v42, v42, v176
    v_add_f32 v43, v43, v177
    v_add_f32 v44, v44, v178
    v_add_f32 v42, v42, v179
    v_add_f32 v43, v43, v180
    v_add_f32 v44, v44, v181
    v_add_f32 v42, v42, v182
    v_add_f32 v43, v43, v183
    v_add_f32 v44, v44, v184
    ds_write_b32 v12, v42 offset:256
    v_mul_f32 v176, v128, v43
    v_mul_f32 v177, v129, v43
    v_mul_f32 v178, v130, v43
    v_mul_f32 v179, v131, v43
    v_mul_f32 v180, v132, v43
    v_mul_f32 v181, v133, v43
    v_mul_f32 v182, v134, v43
    v_mul_f32 v183, v135, v43
    v_mul_f32 v184, v136, v43
    v_mul_f32 v185, v137, v43
    v_mul_f32 v186, v138, v43
    v_mul_f32 v187, v139, v43
    v_mul_f32 v188, v140, v43
    v_mul_f32 v189, v141, v43
    v_mul_f32 v190, v142, v43
    v_mul_f32 v191, v143, v43
    v_fma_f32 v80, v80, v112, v176
    v_fma_f32 v81, v81, v113, v177
    v_fma_f32 v82, v82, v114, v178
    v_fma_f32 v83, v83, v115, v179
    v_fma_f32 v84, v84, v116, v180
    v_fma_f32 v85, v85, v117, v181
    v_fma_f32 v86, v86, v118, v182
    v_fma_f32 v87, v87, v119, v183
    v_fma_f32 v88, v88, v120, v184
    v_fma_f32 v89, v89, v121, v185
    v_fma_f32 v90, v90, v122, v186
    v_fma_f32 v91, v91, v123, v187
    v_fma_f32 v92, v92, v124, v188
    v_fma_f32 v93, v93, v125, v189
    v_fma_f32 v94, v94, v126, v190
    v_fma_f32 v95, v95, v127, v191
    v_cvt_pk_bf16_f32 v200, v80, v81
    v_cvt_pk_bf16_f32 v201, v82, v83
    v_cvt_pk_bf16_f32 v202, v84, v85
    v_cvt_pk_bf16_f32 v203, v86, v87
    v_cvt_pk_bf16_f32 v204, v88, v89
    v_cvt_pk_bf16_f32 v205, v90, v91
    v_cvt_pk_bf16_f32 v206, v92, v93
    v_cvt_pk_bf16_f32 v207, v94, v95
    v_lshlrev_b32 v80, 16, v200
    v_and_b32 v81, 0xffff0000, v200
    v_lshlrev_b32 v82, 16, v201
    v_and_b32 v83, 0xffff0000, v201
    v_lshlrev_b32 v84, 16, v202
    v_and_b32 v85, 0xffff0000, v202
    v_lshlrev_b32 v86, 16, v203
    v_and_b32 v87, 0xffff0000, v203
    v_lshlrev_b32 v88, 16, v204
    v_and_b32 v89, 0xffff0000, v204
    v_lshlrev_b32 v90, 16, v205
    v_and_b32 v91, 0xffff0000, v205
    v_lshlrev_b32 v92, 16, v206
    v_and_b32 v93, 0xffff0000, v206
    v_lshlrev_b32 v94, 16, v207
    v_and_b32 v95, 0xffff0000, v207
    v_min_f32 v176, 0, v80
    v_min_f32 v177, 0, v81
    v_min_f32 v178, 0, v82
    v_min_f32 v179, 0, v83
    v_min_f32 v180, 0, v84
    v_min_f32 v181, 0, v85
    v_min_f32 v182, 0, v86
    v_min_f32 v183, 0, v87
    v_min_f32 v184, 0, v88
    v_min_f32 v185, 0, v89
    v_min_f32 v186, 0, v90
    v_min_f32 v187, 0, v91
    v_min_f32 v188, 0, v92
    v_min_f32 v189, 0, v93
    v_min_f32 v190, 0, v94
    v_min_f32 v191, 0, v95
    v_mul_f32 v176, 0x3fb8aa3b, v176
    v_mul_f32 v177, 0x3fb8aa3b, v177
    v_mul_f32 v178, 0x3fb8aa3b, v178
    v_mul_f32 v179, 0x3fb8aa3b, v179
    v_mul_f32 v180, 0x3fb8aa3b, v180
    v_mul_f32 v181, 0x3fb8aa3b, v181
    v_mul_f32 v182, 0x3fb8aa3b, v182
    v_mul_f32 v183, 0x3fb8aa3b, v183
    v_mul_f32 v184, 0x3fb8aa3b, v184
    v_mul_f32 v185, 0x3fb8aa3b, v185
    v_mul_f32 v186, 0x3fb8aa3b, v186
    v_mul_f32 v187, 0x3fb8aa3b, v187
    v_mul_f32 v188, 0x3fb8aa3b, v188
    v_mul_f32 v189, 0x3fb8aa3b, v189
    v_mul_f32 v190, 0x3fb8aa3b, v190
    v_mul_f32 v191, 0x3fb8aa3b, v191
    v_exp_f32 v176, v176
    v_exp_f32 v177, v177
    v_exp_f32 v178, v178
    v_exp_f32 v179, v179
    v_exp_f32 v180, v180
    v_exp_f32 v181, v181
    v_exp_f32 v182, v182
    v_exp_f32 v183, v183
    v_exp_f32 v184, v184
    v_exp_f32 v185, v185
    v_exp_f32 v186, v186
    v_exp_f32 v187, v187
    v_exp_f32 v188, v188
    v_exp_f32 v189, v189
    v_exp_f32 v190, v190
    v_exp_f32 v191, v191
    v_max_f32 v80, 0, v80
    v_max_f32 v81, 0, v81
    v_max_f32 v82, 0, v82
    v_max_f32 v83, 0, v83
    v_max_f32 v84, 0, v84
    v_max_f32 v85, 0, v85
    v_max_f32 v86, 0, v86
    v_max_f32 v87, 0, v87
    v_max_f32 v88, 0, v88
    v_max_f32 v89, 0, v89
    v_max_f32 v90, 0, v90
    v_max_f32 v91, 0, v91
    v_max_f32 v92, 0, v92
    v_max_f32 v93, 0, v93
    v_max_f32 v94, 0, v94
    v_max_f32 v95, 0, v95
    v_add_f32 v80, 0x358637bd, v80
    v_add_f32 v81, 0x358637bd, v81
    v_add_f32 v82, 0x358637bd, v82
    v_add_f32 v83, 0x358637bd, v83
    v_add_f32 v84, 0x358637bd, v84
    v_add_f32 v85, 0x358637bd, v85
    v_add_f32 v86, 0x358637bd, v86
    v_add_f32 v87, 0x358637bd, v87
    v_add_f32 v88, 0x358637bd, v88
    v_add_f32 v89, 0x358637bd, v89
    v_add_f32 v90, 0x358637bd, v90
    v_add_f32 v91, 0x358637bd, v91
    v_add_f32 v92, 0x358637bd, v92
    v_add_f32 v93, 0x358637bd, v93
    v_add_f32 v94, 0x358637bd, v94
    v_add_f32 v95, 0x358637bd, v95
    v_add_f32 v80, v80, v176
    v_add_f32 v81, v81, v177
    v_add_f32 v82, v82, v178
    v_add_f32 v83, v83, v179
    v_add_f32 v84, v84, v180
    v_add_f32 v85, v85, v181
    v_add_f32 v86, v86, v182
    v_add_f32 v87, v87, v183
    v_add_f32 v88, v88, v184
    v_add_f32 v89, v89, v185
    v_add_f32 v90, v90, v186
    v_add_f32 v91, v91, v187
    v_add_f32 v92, v92, v188
    v_add_f32 v93, v93, v189
    v_add_f32 v94, v94, v190
    v_add_f32 v95, v95, v191
    v_cvt_pk_bf16_f32 v200, v80, v81
    v_cvt_pk_bf16_f32 v201, v82, v83
    v_cvt_pk_bf16_f32 v202, v84, v85
    v_cvt_pk_bf16_f32 v203, v86, v87
    v_cvt_pk_bf16_f32 v204, v88, v89
    v_cvt_pk_bf16_f32 v205, v90, v91
    v_cvt_pk_bf16_f32 v206, v92, v93
    v_cvt_pk_bf16_f32 v207, v94, v95
    v_mul_f32 v176, v128, v44
    v_mul_f32 v177, v129, v44
    v_mul_f32 v178, v130, v44
    v_mul_f32 v179, v131, v44
    v_mul_f32 v180, v132, v44
    v_mul_f32 v181, v133, v44
    v_mul_f32 v182, v134, v44
    v_mul_f32 v183, v135, v44
    v_mul_f32 v184, v136, v44
    v_mul_f32 v185, v137, v44
    v_mul_f32 v186, v138, v44
    v_mul_f32 v187, v139, v44
    v_mul_f32 v188, v140, v44
    v_mul_f32 v189, v141, v44
    v_mul_f32 v190, v142, v44
    v_mul_f32 v191, v143, v44
    v_fma_f32 v96, v96, v112, v176
    v_fma_f32 v97, v97, v113, v177
    v_fma_f32 v98, v98, v114, v178
    v_fma_f32 v99, v99, v115, v179
    v_fma_f32 v100, v100, v116, v180
    v_fma_f32 v101, v101, v117, v181
    v_fma_f32 v102, v102, v118, v182
    v_fma_f32 v103, v103, v119, v183
    v_fma_f32 v104, v104, v120, v184
    v_fma_f32 v105, v105, v121, v185
    v_fma_f32 v106, v106, v122, v186
    v_fma_f32 v107, v107, v123, v187
    v_fma_f32 v108, v108, v124, v188
    v_fma_f32 v109, v109, v125, v189
    v_fma_f32 v110, v110, v126, v190
    v_fma_f32 v111, v111, v127, v191
    v_cvt_pk_bf16_f32 v208, v96, v97
    v_cvt_pk_bf16_f32 v209, v98, v99
    v_cvt_pk_bf16_f32 v210, v100, v101
    v_cvt_pk_bf16_f32 v211, v102, v103
    v_cvt_pk_bf16_f32 v212, v104, v105
    v_cvt_pk_bf16_f32 v213, v106, v107
    v_cvt_pk_bf16_f32 v214, v108, v109
    v_cvt_pk_bf16_f32 v215, v110, v111
    v_mov_b32 v13, 0
    v_dot2_f32_bf16 v13, v200, v45, v13
    v_dot2_f32_bf16 v13, v201, v45, v13
    v_dot2_f32_bf16 v13, v202, v45, v13
    v_dot2_f32_bf16 v13, v203, v45, v13
    v_dot2_f32_bf16 v13, v204, v45, v13
    v_dot2_f32_bf16 v13, v205, v45, v13
    v_dot2_f32_bf16 v13, v206, v45, v13
    v_dot2_f32_bf16 v13, v207, v45, v13
    s_nop 1
    v_mfma_f32_32x32x16_bf16 v[216:231], v[200:203], v[208:211], 0
    v_mfma_f32_32x32x16_bf16 v[216:231], v[204:207], v[212:215], v[216:231]
    s_waitcnt lgkmcnt(0)
    ds_read_b128 v[144:147], v14 offset:256
    ds_read_b128 v[148:151], v14 offset:288
    ds_read_b128 v[152:155], v14 offset:320
    ds_read_b128 v[156:159], v14 offset:352
    v_mov_b32 v8, v13
    s_nop 1
    v_permlane32_swap_b32 v13, v8
    s_nop 0
    v_add_f32 v13, v13, v8
    s_mul_i32 s38, s32, 4352
    s_add_u32 s38, s38, 90112
    v_lshlrev_b32 v11, 2, v1
    v_add_u32 v11, s38, v11
    v_lshlrev_b32 v12, 2, v2
    v_add_u32 v12, s38, v12
    s_nop 7
    ds_write_b32 v11, v216 offset:0
    ds_write_b32 v11, v217 offset:256
    ds_write_b32 v11, v218 offset:512
    ds_write_b32 v11, v219 offset:768
    ds_write_b32 v11, v220 offset:1024
    ds_write_b32 v11, v221 offset:1280
    ds_write_b32 v11, v222 offset:1536
    ds_write_b32 v11, v223 offset:1792
    ds_write_b32 v11, v224 offset:2048
    ds_write_b32 v11, v225 offset:2304
    ds_write_b32 v11, v226 offset:2560
    ds_write_b32 v11, v227 offset:2816
    ds_write_b32 v11, v228 offset:3072
    ds_write_b32 v11, v229 offset:3328
    ds_write_b32 v11, v230 offset:3584
    ds_write_b32 v11, v231 offset:3840
    ds_write_b32 v12, v13 offset:4096
    s_waitcnt lgkmcnt(0)
    s_barrier
    v_lshrrev_b32 v8, 7, v0
    v_bfe_u32 v11, v0, 3, 4
    v_and_b32 v12, 7, v0
    v_lshlrev_b32 v12, 1, v12
    v_lshl_add_u32 v12, v8, 4, v12
    v_and_b32 v13, 3, v12
    v_lshrrev_b32 v14, 3, v12
    v_lshl_add_u32 v13, v14, 2, v13
    v_bfe_u32 v14, v12, 2, 1
    v_lshl_add_u32 v11, v8, 4, v11
    v_lshl_add_u32 v11, v14, 5, v11
    v_lshlrev_b32 v13, 8, v13
    v_lshl_add_u32 v13, v11, 2, v13
    v_add_u32 v13, 90112, v13
    v_and_b32 v12, 31, v0
    v_lshlrev_b32 v12, 2, v12
    v_add_u32 v12, 94208, v12
    ds_read_b32 v176, v13 offset:0
    ds_read_b32 v177, v13 offset:256
    ds_read_b32 v184, v12 offset:0
    ds_read_b32 v178, v13 offset:4352
    ds_read_b32 v179, v13 offset:4608
    ds_read_b32 v185, v12 offset:4352
    ds_read_b32 v180, v13 offset:8704
    ds_read_b32 v181, v13 offset:8960
    ds_read_b32 v186, v12 offset:8704
    ds_read_b32 v182, v13 offset:13056
    ds_read_b32 v183, v13 offset:13312
    ds_read_b32 v187, v12 offset:13056
    s_waitcnt lgkmcnt(0)
    v_add_f32 v176, v176, v178
    v_add_f32 v180, v180, v182
    v_add_f32 v177, v177, v179
    v_add_f32 v181, v181, v183
    v_add_f32 v184, v184, v185
    v_add_f32 v186, v186, v187
    v_add_f32 v176, v176, v180
    v_add_f32 v177, v177, v181
    v_add_f32 v184, v184, v186
    s_lshl_b32 s40, s31, 4
    s_add_u32 s41, s40, s30
    s_mul_i32 s41, s41, 2304
    s_add_u32 s41, s41, 10485760
    s_mul_i32 s40, s40, 2304
    s_add_u32 s40, s40, 10485760
    v_lshlrev_b32 v13, 3, v0
    v_lshlrev_b32 v14, 2, v0
    v_add_u32 v14, 2048, v14
    buffer_store_dwordx2 v[176:177], v13, s[16:19], s41 offen sc1
    v_cmp_gt_u32 vcc, 32, v0
    s_and_saveexec_b64 s[42:43], vcc
    s_cbranch_execz k1_noz
    buffer_store_dword v184, v14, s[16:19], s41 offen sc1
k1_noz:
    s_mov_b64 exec, s[42:43]
    s_waitcnt vmcnt(0)
    s_barrier
    v_cmp_eq_u32 vcc, 0, v0
    s_and_saveexec_b64 s[42:43], vcc
    s_cbranch_execz k1_noatom
    v_mov_b32 v188, 1
    v_lshlrev_b32 v189, 2, v0
    s_lshl_b32 s44, s31, 4
    buffer_atomic_add v188, v189, s[20:23], s44 offen sc0 sc1
k1_noatom:
    s_mov_b64 exec, s[42:43]
    v_mul_f32 v144, v10, v144
    v_mul_f32 v145, v10, v145
    v_mul_f32 v146, v10, v146
    v_mul_f32 v147, v10, v147
    v_mul_f32 v148, v10, v148
    v_mul_f32 v149, v10, v149
    v_mul_f32 v150, v10, v150
    v_mul_f32 v151, v10, v151
    v_mul_f32 v152, v10, v152
    v_mul_f32 v153, v10, v153
    v_mul_f32 v154, v10, v154
    v_mul_f32 v155, v10, v155
    v_mul_f32 v156, v10, v156
    v_mul_f32 v157, v10, v157
    v_mul_f32 v158, v10, v158
    v_mul_f32 v159, v10, v159
    v_fma_f32 v64, v64, v9, v144
    v_fma_f32 v65, v65, v9, v145
    v_fma_f32 v66, v66, v9, v146
    v_fma_f32 v67, v67, v9, v147
    v_fma_f32 v68, v68, v9, v148
    v_fma_f32 v69, v69, v9, v149
    v_fma_f32 v70, v70, v9, v150
    v_fma_f32 v71, v71, v9, v151
    v_fma_f32 v72, v72, v9, v152
    v_fma_f32 v73, v73, v9, v153
    v_fma_f32 v74, v74, v9, v154
    v_fma_f32 v75, v75, v9, v155
    v_fma_f32 v76, v76, v9, v156
    v_fma_f32 v77, v77, v9, v157
    v_fma_f32 v78, v78, v9, v158
    v_fma_f32 v79, v79, v9, v159
    v_cvt_pk_bf16_f32 v192, v64, v65
    v_cvt_pk_bf16_f32 v193, v66, v67
    v_cvt_pk_bf16_f32 v194, v68, v69
    v_cvt_pk_bf16_f32 v195, v70, v71
    v_cvt_pk_bf16_f32 v196, v72, v73
    v_cvt_pk_bf16_f32 v197, v74, v75
    v_cvt_pk_bf16_f32 v198, v76, v77
    v_cvt_pk_bf16_f32 v199, v78, v79
    v_lshlrev_b32 v64, 16, v192
    v_and_b32 v65, 0xffff0000, v192
    v_lshlrev_b32 v66, 16, v193
    v_and_b32 v67, 0xffff0000, v193
    v_lshlrev_b32 v68, 16, v194
    v_and_b32 v69, 0xffff0000, v194
    v_lshlrev_b32 v70, 16, v195
    v_and_b32 v71, 0xffff0000, v195
    v_lshlrev_b32 v72, 16, v196
    v_and_b32 v73, 0xffff0000, v196
    v_lshlrev_b32 v74, 16, v197
    v_and_b32 v75, 0xffff0000, v197
    v_lshlrev_b32 v76, 16, v198
    v_and_b32 v77, 0xffff0000, v198
    v_lshlrev_b32 v78, 16, v199
    v_and_b32 v79, 0xffff0000, v199
    v_min_f32 v216, 0, v64
    v_min_f32 v217, 0, v65
    v_min_f32 v218, 0, v66
    v_min_f32 v219, 0, v67
    v_min_f32 v220, 0, v68
    v_min_f32 v221, 0, v69
    v_min_f32 v222, 0, v70
    v_min_f32 v223, 0, v71
    v_min_f32 v224, 0, v72
    v_min_f32 v225, 0, v73
    v_min_f32 v226, 0, v74
    v_min_f32 v227, 0, v75
    v_min_f32 v228, 0, v76
    v_min_f32 v229, 0, v77
    v_min_f32 v230, 0, v78
    v_min_f32 v231, 0, v79
    v_mul_f32 v216, 0x3fb8aa3b, v216
    v_mul_f32 v217, 0x3fb8aa3b, v217
    v_mul_f32 v218, 0x3fb8aa3b, v218
    v_mul_f32 v219, 0x3fb8aa3b, v219
    v_mul_f32 v220, 0x3fb8aa3b, v220
    v_mul_f32 v221, 0x3fb8aa3b, v221
    v_mul_f32 v222, 0x3fb8aa3b, v222
    v_mul_f32 v223, 0x3fb8aa3b, v223
    v_mul_f32 v224, 0x3fb8aa3b, v224
    v_mul_f32 v225, 0x3fb8aa3b, v225
    v_mul_f32 v226, 0x3fb8aa3b, v226
    v_mul_f32 v227, 0x3fb8aa3b, v227
    v_mul_f32 v228, 0x3fb8aa3b, v228
    v_mul_f32 v229, 0x3fb8aa3b, v229
    v_mul_f32 v230, 0x3fb8aa3b, v230
    v_mul_f32 v231, 0x3fb8aa3b, v231
    v_exp_f32 v216, v216
    v_exp_f32 v217, v217
    v_exp_f32 v218, v218
    v_exp_f32 v219, v219
    v_exp_f32 v220, v220
    v_exp_f32 v221, v221
    v_exp_f32 v222, v222
    v_exp_f32 v223, v223
    v_exp_f32 v224, v224
    v_exp_f32 v225, v225
    v_exp_f32 v226, v226
    v_exp_f32 v227, v227
    v_exp_f32 v228, v228
    v_exp_f32 v229, v229
    v_exp_f32 v230, v230
    v_exp_f32 v231, v231
    v_max_f32 v64, 0, v64
    v_max_f32 v65, 0, v65
    v_max_f32 v66, 0, v66
    v_max_f32 v67, 0, v67
    v_max_f32 v68, 0, v68
    v_max_f32 v69, 0, v69
    v_max_f32 v70, 0, v70
    v_max_f32 v71, 0, v71
    v_max_f32 v72, 0, v72
    v_max_f32 v73, 0, v73
    v_max_f32 v74, 0, v74
    v_max_f32 v75, 0, v75
    v_max_f32 v76, 0, v76
    v_max_f32 v77, 0, v77
    v_max_f32 v78, 0, v78
    v_max_f32 v79, 0, v79
    v_add_f32 v64, 0x358637bd, v64
    v_add_f32 v65, 0x358637bd, v65
    v_add_f32 v66, 0x358637bd, v66
    v_add_f32 v67, 0x358637bd, v67
    v_add_f32 v68, 0x358637bd, v68
    v_add_f32 v69, 0x358637bd, v69
    v_add_f32 v70, 0x358637bd, v70
    v_add_f32 v71, 0x358637bd, v71
    v_add_f32 v72, 0x358637bd, v72
    v_add_f32 v73, 0x358637bd, v73
    v_add_f32 v74, 0x358637bd, v74
    v_add_f32 v75, 0x358637bd, v75
    v_add_f32 v76, 0x358637bd, v76
    v_add_f32 v77, 0x358637bd, v77
    v_add_f32 v78, 0x358637bd, v78
    v_add_f32 v79, 0x358637bd, v79
    v_add_f32 v64, v64, v216
    v_add_f32 v65, v65, v217
    v_add_f32 v66, v66, v218
    v_add_f32 v67, v67, v219
    v_add_f32 v68, v68, v220
    v_add_f32 v69, v69, v221
    v_add_f32 v70, v70, v222
    v_add_f32 v71, v71, v223
    v_add_f32 v72, v72, v224
    v_add_f32 v73, v73, v225
    v_add_f32 v74, v74, v226
    v_add_f32 v75, v75, v227
    v_add_f32 v76, v76, v228
    v_add_f32 v77, v77, v229
    v_add_f32 v78, v78, v230
    v_add_f32 v79, v79, v231
    v_cvt_pk_bf16_f32 v192, v64, v65
    v_cvt_pk_bf16_f32 v193, v66, v67
    v_cvt_pk_bf16_f32 v194, v68, v69
    v_cvt_pk_bf16_f32 v195, v70, v71
    v_cvt_pk_bf16_f32 v196, v72, v73
    v_cvt_pk_bf16_f32 v197, v74, v75
    v_cvt_pk_bf16_f32 v198, v76, v77
    v_cvt_pk_bf16_f32 v199, v78, v79
    v_add_u32 v11, s47, v2
    v_lshlrev_b32 v11, 10, v11
    v_lshl_add_u32 v11, v3, 4, v11
    s_lshl_b32 s39, s31, 6
    v_permlane32_swap_b32 v192, v194
    v_permlane32_swap_b32 v193, v195
    v_permlane32_swap_b32 v196, v198
    v_permlane32_swap_b32 v197, v199
    buffer_store_dwordx4 v[192:195], v11, s[16:19], s39 offen offset:0
    buffer_store_dwordx4 v[196:199], v11, s[16:19], s39 offen offset:32
    v_cmp_eq_u32 vcc, 0, v0
    s_and_saveexec_b64 s[42:43], vcc
    s_cbranch_execz k1_nobc
    s_waitcnt vmcnt(0)
    v_mov_b32 v189, 86016
    ds_write_b32 v189, v188
    s_waitcnt lgkmcnt(0)
k1_nobc:
    s_mov_b64 exec, s[42:43]
    s_barrier
    v_mov_b32 v189, 86016
    ds_read_b32 v188, v189
    s_waitcnt lgkmcnt(0)
    v_readfirstlane_b32 s45, v188
    s_cmp_lg_u32 s45, 15
    s_cbranch_scc1 k1_end
    s_add_u32 s46, s40, 0
    buffer_load_dwordx2 v[128:129], v13, s[16:19], s46 offen sc1
    s_add_u32 s46, s40, 2304
    buffer_load_dwordx2 v[130:131], v13, s[16:19], s46 offen sc1
    s_add_u32 s46, s40, 4608
    buffer_load_dwordx2 v[132:133], v13, s[16:19], s46 offen sc1
    s_add_u32 s46, s40, 6912
    buffer_load_dwordx2 v[134:135], v13, s[16:19], s46 offen sc1
    s_add_u32 s46, s40, 9216
    buffer_load_dwordx2 v[136:137], v13, s[16:19], s46 offen sc1
    s_add_u32 s46, s40, 11520
    buffer_load_dwordx2 v[138:139], v13, s[16:19], s46 offen sc1
    s_add_u32 s46, s40, 13824
    buffer_load_dwordx2 v[140:141], v13, s[16:19], s46 offen sc1
    s_add_u32 s46, s40, 16128
    buffer_load_dwordx2 v[142:143], v13, s[16:19], s46 offen sc1
    s_add_u32 s46, s40, 18432
    buffer_load_dwordx2 v[144:145], v13, s[16:19], s46 offen sc1
    s_add_u32 s46, s40, 20736
    buffer_load_dwordx2 v[146:147], v13, s[16:19], s46 offen sc1
    s_add_u32 s46, s40, 23040
    buffer_load_dwordx2 v[148:149], v13, s[16:19], s46 offen sc1
    s_add_u32 s46, s40, 25344
    buffer_load_dwordx2 v[150:151], v13, s[16:19], s46 offen sc1
    s_add_u32 s46, s40, 27648
    buffer_load_dwordx2 v[152:153], v13, s[16:19], s46 offen sc1
    s_add_u32 s46, s40, 29952
    buffer_load_dwordx2 v[154:155], v13, s[16:19], s46 offen sc1
    s_add_u32 s46, s40, 32256
    buffer_load_dwordx2 v[156:157], v13, s[16:19], s46 offen sc1
    s_add_u32 s46, s40, 34560
    buffer_load_dwordx2 v[158:159], v13, s[16:19], s46 offen sc1
    s_add_u32 s46, s40, 0
    buffer_load_dword v160, v14, s[16:19], s46 offen sc1
    s_add_u32 s46, s40, 2304
    buffer_load_dword v161, v14, s[16:19], s46 offen sc1
    s_add_u32 s46, s40, 4608
    buffer_load_dword v162, v14, s[16:19], s46 offen sc1
    s_add_u32 s46, s40, 6912
    buffer_load_dword v163, v14, s[16:19], s46 offen sc1
    s_add_u32 s46, s40, 9216
    buffer_load_dword v164, v14, s[16:19], s46 offen sc1
    s_add_u32 s46, s40, 11520
    buffer_load_dword v165, v14, s[16:19], s46 offen sc1
    s_add_u32 s46, s40, 13824
    buffer_load_dword v166, v14, s[16:19], s46 offen sc1
    s_add_u32 s46, s40, 16128
    buffer_load_dword v167, v14, s[16:19], s46 offen sc1
    s_add_u32 s46, s40, 18432
    buffer_load_dword v168, v14, s[16:19], s46 offen sc1
    s_add_u32 s46, s40, 20736
    buffer_load_dword v169, v14, s[16:19], s46 offen sc1
    s_add_u32 s46, s40, 23040
    buffer_load_dword v170, v14, s[16:19], s46 offen sc1
    s_add_u32 s46, s40, 25344
    buffer_load_dword v171, v14, s[16:19], s46 offen sc1
    s_add_u32 s46, s40, 27648
    buffer_load_dword v172, v14, s[16:19], s46 offen sc1
    s_add_u32 s46, s40, 29952
    buffer_load_dword v173, v14, s[16:19], s46 offen sc1
    s_add_u32 s46, s40, 32256
    buffer_load_dword v174, v14, s[16:19], s46 offen sc1
    s_add_u32 s46, s40, 34560
    buffer_load_dword v175, v14, s[16:19], s46 offen sc1
    s_waitcnt vmcnt(0)
    v_add_f32 v128, v128, v130
    v_add_f32 v129, v129, v131
    v_add_f32 v160, v160, v161
    v_add_f32 v128, v128, v132
    v_add_f32 v129, v129, v133
    v_add_f32 v160, v160, v162
    v_add_f32 v128, v128, v134
    v_add_f32 v129, v129, v135
    v_add_f32 v160, v160, v163
    v_add_f32 v128, v128, v136
    v_add_f32 v129, v129, v137
    v_add_f32 v160, v160, v164
    v_add_f32 v128, v128, v138
    v_add_f32 v129, v129, v139
    v_add_f32 v160, v160, v165
    v_add_f32 v128, v128, v140
    v_add_f32 v129, v129, v141
    v_add_f32 v160, v160, v166
    v_add_f32 v128, v128, v142
    v_add_f32 v129, v129, v143
    v_add_f32 v160, v160, v167
    v_add_f32 v128, v128, v144
    v_add_f32 v129, v129, v145
    v_add_f32 v160, v160, v168
    v_add_f32 v128, v128, v146
    v_add_f32 v129, v129, v147
    v_add_f32 v160, v160, v169
    v_add_f32 v128, v128, v148
    v_add_f32 v129, v129, v149
    v_add_f32 v160, v160, v170
    v_add_f32 v128, v128, v150
    v_add_f32 v129, v129, v151
    v_add_f32 v160, v160, v171
    v_add_f32 v128, v128, v152
    v_add_f32 v129, v129, v153
    v_add_f32 v160, v160, v172
    v_add_f32 v128, v128, v154
    v_add_f32 v129, v129, v155
    v_add_f32 v160, v160, v173
    v_add_f32 v128, v128, v156
    v_add_f32 v129, v129, v157
    v_add_f32 v160, v160, v174
    v_add_f32 v128, v128, v158
    v_add_f32 v129, v129, v159
    v_add_f32 v160, v160, v175
    v_cvt_pk_bf16_f32 v128, v128, v129
    v_cvt_pk_bf16_f32 v160, v160, v160
    v_lshlrev_b32 v13, 2, v0
    s_lshl_b32 s46, s31, 10
    s_add_u32 s46, s46, 12582912
    buffer_store_dword v128, v13, s[16:19], s46 offen
    v_lshlrev_b32 v13, 1, v0
    s_lshl_b32 s46, s31, 6
    s_add_u32 s46, s46, 12599296
    v_cmp_gt_u32 vcc, 32, v0
    s_and_saveexec_b64 s[42:43], vcc
    s_cbranch_execz k1_end
    buffer_store_short v160, v13, s[16:19], s46 offen
k1_end:
    s_endpgm
.globl k2_kernel
.p2align 8
.type k2_kernel,@function
k2_kernel:
    s_cmp_ge_u32 s2, 256
    s_cbranch_scc1 k2_end
    s_load_dwordx2 s[4:5], s[0:1], 0
    s_load_dwordx2 s[6:7], s[0:1], 16
    s_load_dwordx2 s[26:27], s[0:1], 72
    s_and_b32 s28, s2, 7
    s_lshr_b32 s29, s2, 3
    s_lshl_b32 s30, s28, 2
    s_and_b32 s31, s29, 3
    s_add_u32 s30, s30, s31
    s_lshr_b32 s31, s29, 2
    v_and_b32 v1, 63, v0
    v_lshrrev_b32 v12, 6, v0
    v_and_b32 v2, 31, v1
    v_lshrrev_b32 v3, 5, v1
    v_readfirstlane_b32 s32, v12
    s_waitcnt lgkmcnt(0)
    s_mov_b32 s8, s4
    s_and_b32 s9, s5, 0xffff
    s_mov_b32 s10, 2097152
    s_mov_b32 s11, 0x00020000
    s_mov_b32 s12, s6
    s_and_b32 s13, s7, 0xffff
    s_mov_b32 s14, 524288
    s_mov_b32 s15, 0x00020000
    s_mov_b32 s16, s26
    s_and_b32 s17, s27, 0xffff
    s_mov_b32 s18, 16777216
    s_mov_b32 s19, 0x00020000
    s_and_b32 s33, s32, 1
    s_lshr_b32 s34, s32, 1
    s_lshl_b32 s35, s30, 6
    s_lshl_b32 s36, s33, 5
    s_add_u32 s35, s35, s36
    s_cmp_lg_u32 s32, 4
    s_cbranch_scc1 k2_compute
    v_lshrrev_b32 v12, 3, v1
    v_mul_u32_u24 v4, 1024, v12
    v_bfe_u32 v13, v1, 4, 1
    v_lshlrev_b32 v13, 2, v13
    v_and_b32 v14, 7, v1
    v_xor_b32 v14, v14, v13
    v_lshl_add_u32 v4, v14, 4, v4
    v_lshlrev_b32 v6, 4, v1
    s_lshl_b32 s38, s30, 16
    s_lshl_b32 s39, s31, 7
    s_mov_b32 m0, 132096
    s_mov_b32 s36, 12582912
    buffer_load_dwordx4 v6, s[16:19], s36 offen lds
    s_mov_b32 m0, 133120
    s_mov_b32 s36, 12583936
    buffer_load_dwordx4 v6, s[16:19], s36 offen lds
    s_mov_b32 m0, 134144
    s_mov_b32 s36, 12584960
    buffer_load_dwordx4 v6, s[16:19], s36 offen lds
    s_mov_b32 m0, 135168
    s_mov_b32 s36, 12585984
    buffer_load_dwordx4 v6, s[16:19], s36 offen lds
    s_mov_b32 m0, 136192
    s_mov_b32 s36, 12587008
    buffer_load_dwordx4 v6, s[16:19], s36 offen lds
    s_mov_b32 m0, 137216
    s_mov_b32 s36, 12588032
    buffer_load_dwordx4 v6, s[16:19], s36 offen lds
    s_mov_b32 m0, 138240
    s_mov_b32 s36, 12589056
    buffer_load_dwordx4 v6, s[16:19], s36 offen lds
    s_mov_b32 m0, 139264
    s_mov_b32 s36, 12590080
    buffer_load_dwordx4 v6, s[16:19], s36 offen lds
    s_mov_b32 m0, 140288
    s_mov_b32 s36, 12591104
    buffer_load_dwordx4 v6, s[16:19], s36 offen lds
    s_mov_b32 m0, 141312
    s_mov_b32 s36, 12592128
    buffer_load_dwordx4 v6, s[16:19], s36 offen lds
    s_mov_b32 m0, 142336
    s_mov_b32 s36, 12593152
    buffer_load_dwordx4 v6, s[16:19], s36 offen lds
    s_mov_b32 m0, 143360
    s_mov_b32 s36, 12594176
    buffer_load_dwordx4 v6, s[16:19], s36 offen lds
    s_mov_b32 m0, 144384
    s_mov_b32 s36, 12595200
    buffer_load_dwordx4 v6, s[16:19], s36 offen lds
    s_mov_b32 m0, 145408
    s_mov_b32 s36, 12596224
    buffer_load_dwordx4 v6, s[16:19], s36 offen lds
    s_mov_b32 m0, 146432
    s_mov_b32 s36, 12597248
    buffer_load_dwordx4 v6, s[16:19], s36 offen lds
    s_mov_b32 m0, 147456
    s_mov_b32 s36, 12598272
    buffer_load_dwordx4 v6, s[16:19], s36 offen lds
    s_mov_b32 m0, 148480
    s_mov_b32 s36, 12599296
    buffer_load_dwordx4 v6, s[16:19], s36 offen lds
    s_mov_b32 m0, 65536
    s_add_u32 s36, s38, 0
    buffer_load_dwordx4 v6, s[16:19], s36 offen lds
    s_mov_b32 m0, 66576
    s_add_u32 s36, s38, 1024
    buffer_load_dwordx4 v6, s[16:19], s36 offen lds
    s_mov_b32 m0, 67616
    s_add_u32 s36, s38, 2048
    buffer_load_dwordx4 v6, s[16:19], s36 offen lds
    s_mov_b32 m0, 68656
    s_add_u32 s36, s38, 3072
    buffer_load_dwordx4 v6, s[16:19], s36 offen lds
    s_mov_b32 m0, 69696
    s_add_u32 s36, s38, 4096
    buffer_load_dwordx4 v6, s[16:19], s36 offen lds
    s_mov_b32 m0, 70736
    s_add_u32 s36, s38, 5120
    buffer_load_dwordx4 v6, s[16:19], s36 offen lds
    s_mov_b32 m0, 71776
    s_add_u32 s36, s38, 6144
    buffer_load_dwordx4 v6, s[16:19], s36 offen lds
    s_mov_b32 m0, 72816
    s_add_u32 s36, s38, 7168
    buffer_load_dwordx4 v6, s[16:19], s36 offen lds
    s_mov_b32 m0, 73856
    s_add_u32 s36, s38, 8192
    buffer_load_dwordx4 v6, s[16:19], s36 offen lds
    s_mov_b32 m0, 74896
    s_add_u32 s36, s38, 9216
    buffer_load_dwordx4 v6, s[16:19], s36 offen lds
    s_mov_b32 m0, 75936
    s_add_u32 s36, s38, 10240
    buffer_load_dwordx4 v6, s[16:19], s36 offen lds
    s_mov_b32 m0, 76976
    s_add_u32 s36, s38, 11264
    buffer_load_dwordx4 v6, s[16:19], s36 offen lds
    s_mov_b32 m0, 78016
    s_add_u32 s36, s38, 12288
    buffer_load_dwordx4 v6, s[16:19], s36 offen lds
    s_mov_b32 m0, 79056
    s_add_u32 s36, s38, 13312
    buffer_load_dwordx4 v6, s[16:19], s36 offen lds
    s_mov_b32 m0, 80096
    s_add_u32 s36, s38, 14336
    buffer_load_dwordx4 v6, s[16:19], s36 offen lds
    s_mov_b32 m0, 81136
    s_add_u32 s36, s38, 15360
    buffer_load_dwordx4 v6, s[16:19], s36 offen lds
    s_mov_b32 m0, 82176
    s_add_u32 s36, s38, 16384
    buffer_load_dwordx4 v6, s[16:19], s36 offen lds
    s_mov_b32 m0, 83216
    s_add_u32 s36, s38, 17408
    buffer_load_dwordx4 v6, s[16:19], s36 offen lds
    s_mov_b32 m0, 84256
    s_add_u32 s36, s38, 18432
    buffer_load_dwordx4 v6, s[16:19], s36 offen lds
    s_mov_b32 m0, 85296
    s_add_u32 s36, s38, 19456
    buffer_load_dwordx4 v6, s[16:19], s36 offen lds
    s_mov_b32 m0, 86336
    s_add_u32 s36, s38, 20480
    buffer_load_dwordx4 v6, s[16:19], s36 offen lds
    s_mov_b32 m0, 87376
    s_add_u32 s36, s38, 21504
    buffer_load_dwordx4 v6, s[16:19], s36 offen lds
    s_mov_b32 m0, 88416
    s_add_u32 s36, s38, 22528
    buffer_load_dwordx4 v6, s[16:19], s36 offen lds
    s_mov_b32 m0, 89456
    s_add_u32 s36, s38, 23552
    buffer_load_dwordx4 v6, s[16:19], s36 offen lds
    s_mov_b32 m0, 90496
    s_add_u32 s36, s38, 24576
    buffer_load_dwordx4 v6, s[16:19], s36 offen lds
    s_mov_b32 m0, 91536
    s_add_u32 s36, s38, 25600
    buffer_load_dwordx4 v6, s[16:19], s36 offen lds
    s_mov_b32 m0, 92576
    s_add_u32 s36, s38, 26624
    buffer_load_dwordx4 v6, s[16:19], s36 offen lds
    s_mov_b32 m0, 93616
    s_add_u32 s36, s38, 27648
    buffer_load_dwordx4 v6, s[16:19], s36 offen lds
    s_mov_b32 m0, 94656
    s_add_u32 s36, s38, 28672
    buffer_load_dwordx4 v6, s[16:19], s36 offen lds
    s_mov_b32 m0, 95696
    s_add_u32 s36, s38, 29696
    buffer_load_dwordx4 v6, s[16:19], s36 offen lds
    s_mov_b32 m0, 96736
    s_add_u32 s36, s38, 30720
    buffer_load_dwordx4 v6, s[16:19], s36 offen lds
    s_mov_b32 m0, 97776
    s_add_u32 s36, s38, 31744
    buffer_load_dwordx4 v6, s[16:19], s36 offen lds
    s_mov_b32 m0, 98816
    s_add_u32 s36, s38, 32768
    buffer_load_dwordx4 v6, s[16:19], s36 offen lds
    s_mov_b32 m0, 99856
    s_add_u32 s36, s38, 33792
    buffer_load_dwordx4 v6, s[16:19], s36 offen lds
    s_mov_b32 m0, 100896
    s_add_u32 s36, s38, 34816
    buffer_load_dwordx4 v6, s[16:19], s36 offen lds
    s_mov_b32 m0, 101936
    s_add_u32 s36, s38, 35840
    buffer_load_dwordx4 v6, s[16:19], s36 offen lds
    s_mov_b32 m0, 102976
    s_add_u32 s36, s38, 36864
    buffer_load_dwordx4 v6, s[16:19], s36 offen lds
    s_mov_b32 m0, 104016
    s_add_u32 s36, s38, 37888
    buffer_load_dwordx4 v6, s[16:19], s36 offen lds
    s_mov_b32 m0, 105056
    s_add_u32 s36, s38, 38912
    buffer_load_dwordx4 v6, s[16:19], s36 offen lds
    s_mov_b32 m0, 106096
    s_add_u32 s36, s38, 39936
    buffer_load_dwordx4 v6, s[16:19], s36 offen lds
    s_mov_b32 m0, 107136
    s_add_u32 s36, s38, 40960
    buffer_load_dwordx4 v6, s[16:19], s36 offen lds
    s_mov_b32 m0, 108176
    s_add_u32 s36, s38, 41984
    buffer_load_dwordx4 v6, s[16:19], s36 offen lds
    s_mov_b32 m0, 109216
    s_add_u32 s36, s38, 43008
    buffer_load_dwordx4 v6, s[16:19], s36 offen lds
    s_mov_b32 m0, 110256
    s_add_u32 s36, s38, 44032
    buffer_load_dwordx4 v6, s[16:19], s36 offen lds
    s_mov_b32 m0, 111296
    s_add_u32 s36, s38, 45056
    buffer_load_dwordx4 v6, s[16:19], s36 offen lds
    s_mov_b32 m0, 112336
    s_add_u32 s36, s38, 46080
    buffer_load_dwordx4 v6, s[16:19], s36 offen lds
    s_mov_b32 m0, 113376
    s_add_u32 s36, s38, 47104
    buffer_load_dwordx4 v6, s[16:19], s36 offen lds
    s_mov_b32 m0, 114416
    s_add_u32 s36, s38, 48128
    buffer_load_dwordx4 v6, s[16:19], s36 offen lds
    s_mov_b32 m0, 115456
    s_add_u32 s36, s38, 49152
    buffer_load_dwordx4 v6, s[16:19], s36 offen lds
    s_mov_b32 m0, 116496
    s_add_u32 s36, s38, 50176
    buffer_load_dwordx4 v6, s[16:19], s36 offen lds
    s_mov_b32 m0, 117536
    s_add_u32 s36, s38, 51200
    buffer_load_dwordx4 v6, s[16:19], s36 offen lds
    s_mov_b32 m0, 118576
    s_add_u32 s36, s38, 52224
    buffer_load_dwordx4 v6, s[16:19], s36 offen lds
    s_mov_b32 m0, 119616
    s_add_u32 s36, s38, 53248
    buffer_load_dwordx4 v6, s[16:19], s36 offen lds
    s_mov_b32 m0, 120656
    s_add_u32 s36, s38, 54272
    buffer_load_dwordx4 v6, s[16:19], s36 offen lds
    s_mov_b32 m0, 121696
    s_add_u32 s36, s38, 55296
    buffer_load_dwordx4 v6, s[16:19], s36 offen lds
    s_mov_b32 m0, 122736
    s_add_u32 s36, s38, 56320
    buffer_load_dwordx4 v6, s[16:19], s36 offen lds
    s_mov_b32 m0, 123776
    s_add_u32 s36, s38, 57344
    buffer_load_dwordx4 v6, s[16:19], s36 offen lds
    s_mov_b32 m0, 124816
    s_add_u32 s36, s38, 58368
    buffer_load_dwordx4 v6, s[16:19], s36 offen lds
    s_mov_b32 m0, 125856
    s_add_u32 s36, s38, 59392
    buffer_load_dwordx4 v6, s[16:19], s36 offen lds
    s_mov_b32 m0, 126896
    s_add_u32 s36, s38, 60416
    buffer_load_dwordx4 v6, s[16:19], s36 offen lds
    s_mov_b32 m0, 127936
    s_add_u32 s36, s38, 61440
    buffer_load_dwordx4 v6, s[16:19], s36 offen lds
    s_mov_b32 m0, 128976
    s_add_u32 s36, s38, 62464
    buffer_load_dwordx4 v6, s[16:19], s36 offen lds
    s_mov_b32 m0, 130016
    s_add_u32 s36, s38, 63488
    buffer_load_dwordx4 v6, s[16:19], s36 offen lds
    s_mov_b32 m0, 131056
    s_add_u32 s36, s38, 64512
    buffer_load_dwordx4 v6, s[16:19], s36 offen lds
    s_mov_b32 m0, 0
    s_add_u32 s36, s39, 0
    buffer_load_dwordx4 v4, s[12:15], s36 offen lds
    s_mov_b32 m0, 1024
    s_add_u32 s36, s39, 8192
    buffer_load_dwordx4 v4, s[12:15], s36 offen lds
    s_mov_b32 m0, 2048
    s_add_u32 s36, s39, 16384
    buffer_load_dwordx4 v4, s[12:15], s36 offen lds
    s_mov_b32 m0, 3072
    s_add_u32 s36, s39, 24576
    buffer_load_dwordx4 v4, s[12:15], s36 offen lds
    s_mov_b32 m0, 4096
    s_add_u32 s36, s39, 32768
    buffer_load_dwordx4 v4, s[12:15], s36 offen lds
    s_mov_b32 m0, 5120
    s_add_u32 s36, s39, 40960
    buffer_load_dwordx4 v4, s[12:15], s36 offen lds
    s_mov_b32 m0, 6144
    s_add_u32 s36, s39, 49152
    buffer_load_dwordx4 v4, s[12:15], s36 offen lds
    s_mov_b32 m0, 7168
    s_add_u32 s36, s39, 57344
    buffer_load_dwordx4 v4, s[12:15], s36 offen lds
    s_mov_b32 m0, 8192
    s_add_u32 s36, s39, 65536
    buffer_load_dwordx4 v4, s[12:15], s36 offen lds
    s_mov_b32 m0, 9216
    s_add_u32 s36, s39, 73728
    buffer_load_dwordx4 v4, s[12:15], s36 offen lds
    s_mov_b32 m0, 10240
    s_add_u32 s36, s39, 81920
    buffer_load_dwordx4 v4, s[12:15], s36 offen lds
    s_mov_b32 m0, 11264
    s_add_u32 s36, s39, 90112
    buffer_load_dwordx4 v4, s[12:15], s36 offen lds
    s_mov_b32 m0, 12288
    s_add_u32 s36, s39, 98304
    buffer_load_dwordx4 v4, s[12:15], s36 offen lds
    s_mov_b32 m0, 13312
    s_add_u32 s36, s39, 106496
    buffer_load_dwordx4 v4, s[12:15], s36 offen lds
    s_mov_b32 m0, 14336
    s_add_u32 s36, s39, 114688
    buffer_load_dwordx4 v4, s[12:15], s36 offen lds
    s_mov_b32 m0, 15360
    s_add_u32 s36, s39, 122880
    buffer_load_dwordx4 v4, s[12:15], s36 offen lds
    s_waitcnt vmcnt(16)
    s_barrier
    s_mov_b32 m0, 16384
    s_add_u32 s36, s39, 131072
    buffer_load_dwordx4 v4, s[12:15], s36 offen lds
    s_mov_b32 m0, 17408
    s_add_u32 s36, s39, 139264
    buffer_load_dwordx4 v4, s[12:15], s36 offen lds
    s_mov_b32 m0, 18432
    s_add_u32 s36, s39, 147456
    buffer_load_dwordx4 v4, s[12:15], s36 offen lds
    s_mov_b32 m0, 19456
    s_add_u32 s36, s39, 155648
    buffer_load_dwordx4 v4, s[12:15], s36 offen lds
    s_mov_b32 m0, 20480
    s_add_u32 s36, s39, 163840
    buffer_load_dwordx4 v4, s[12:15], s36 offen lds
    s_mov_b32 m0, 21504
    s_add_u32 s36, s39, 172032
    buffer_load_dwordx4 v4, s[12:15], s36 offen lds
    s_mov_b32 m0, 22528
    s_add_u32 s36, s39, 180224
    buffer_load_dwordx4 v4, s[12:15], s36 offen lds
    s_mov_b32 m0, 23552
    s_add_u32 s36, s39, 188416
    buffer_load_dwordx4 v4, s[12:15], s36 offen lds
    s_mov_b32 m0, 24576
    s_add_u32 s36, s39, 196608
    buffer_load_dwordx4 v4, s[12:15], s36 offen lds
    s_mov_b32 m0, 25600
    s_add_u32 s36, s39, 204800
    buffer_load_dwordx4 v4, s[12:15], s36 offen lds
    s_mov_b32 m0, 26624
    s_add_u32 s36, s39, 212992
    buffer_load_dwordx4 v4, s[12:15], s36 offen lds
    s_mov_b32 m0, 27648
    s_add_u32 s36, s39, 221184
    buffer_load_dwordx4 v4, s[12:15], s36 offen lds
    s_mov_b32 m0, 28672
    s_add_u32 s36, s39, 229376
    buffer_load_dwordx4 v4, s[12:15], s36 offen lds
    s_mov_b32 m0, 29696
    s_add_u32 s36, s39, 237568
    buffer_load_dwordx4 v4, s[12:15], s36 offen lds
    s_mov_b32 m0, 30720
    s_add_u32 s36, s39, 245760
    buffer_load_dwordx4 v4, s[12:15], s36 offen lds
    s_mov_b32 m0, 31744
    s_add_u32 s36, s39, 253952
    buffer_load_dwordx4 v4, s[12:15], s36 offen lds
    s_mov_b32 m0, 32768
    s_add_u32 s36, s39, 262144
    buffer_load_dwordx4 v4, s[12:15], s36 offen lds
    s_mov_b32 m0, 33792
    s_add_u32 s36, s39, 270336
    buffer_load_dwordx4 v4, s[12:15], s36 offen lds
    s_mov_b32 m0, 34816
    s_add_u32 s36, s39, 278528
    buffer_load_dwordx4 v4, s[12:15], s36 offen lds
    s_mov_b32 m0, 35840
    s_add_u32 s36, s39, 286720
    buffer_load_dwordx4 v4, s[12:15], s36 offen lds
    s_mov_b32 m0, 36864
    s_add_u32 s36, s39, 294912
    buffer_load_dwordx4 v4, s[12:15], s36 offen lds
    s_mov_b32 m0, 37888
    s_add_u32 s36, s39, 303104
    buffer_load_dwordx4 v4, s[12:15], s36 offen lds
    s_mov_b32 m0, 38912
    s_add_u32 s36, s39, 311296
    buffer_load_dwordx4 v4, s[12:15], s36 offen lds
    s_mov_b32 m0, 39936
    s_add_u32 s36, s39, 319488
    buffer_load_dwordx4 v4, s[12:15], s36 offen lds
    s_mov_b32 m0, 40960
    s_add_u32 s36, s39, 327680
    buffer_load_dwordx4 v4, s[12:15], s36 offen lds
    s_mov_b32 m0, 41984
    s_add_u32 s36, s39, 335872
    buffer_load_dwordx4 v4, s[12:15], s36 offen lds
    s_mov_b32 m0, 43008
    s_add_u32 s36, s39, 344064
    buffer_load_dwordx4 v4, s[12:15], s36 offen lds
    s_mov_b32 m0, 44032
    s_add_u32 s36, s39, 352256
    buffer_load_dwordx4 v4, s[12:15], s36 offen lds
    s_mov_b32 m0, 45056
    s_add_u32 s36, s39, 360448
    buffer_load_dwordx4 v4, s[12:15], s36 offen lds
    s_mov_b32 m0, 46080
    s_add_u32 s36, s39, 368640
    buffer_load_dwordx4 v4, s[12:15], s36 offen lds
    s_mov_b32 m0, 47104
    s_add_u32 s36, s39, 376832
    buffer_load_dwordx4 v4, s[12:15], s36 offen lds
    s_mov_b32 m0, 48128
    s_add_u32 s36, s39, 385024
    buffer_load_dwordx4 v4, s[12:15], s36 offen lds
    s_mov_b32 m0, 49152
    s_add_u32 s36, s39, 393216
    buffer_load_dwordx4 v4, s[12:15], s36 offen lds
    s_mov_b32 m0, 50176
    s_add_u32 s36, s39, 401408
    buffer_load_dwordx4 v4, s[12:15], s36 offen lds
    s_mov_b32 m0, 51200
    s_add_u32 s36, s39, 409600
    buffer_load_dwordx4 v4, s[12:15], s36 offen lds
    s_mov_b32 m0, 52224
    s_add_u32 s36, s39, 417792
    buffer_load_dwordx4 v4, s[12:15], s36 offen lds
    s_mov_b32 m0, 53248
    s_add_u32 s36, s39, 425984
    buffer_load_dwordx4 v4, s[12:15], s36 offen lds
    s_mov_b32 m0, 54272
    s_add_u32 s36, s39, 434176
    buffer_load_dwordx4 v4, s[12:15], s36 offen lds
    s_mov_b32 m0, 55296
    s_add_u32 s36, s39, 442368
    buffer_load_dwordx4 v4, s[12:15], s36 offen lds
    s_mov_b32 m0, 56320
    s_add_u32 s36, s39, 450560
    buffer_load_dwordx4 v4, s[12:15], s36 offen lds
    s_mov_b32 m0, 57344
    s_add_u32 s36, s39, 458752
    buffer_load_dwordx4 v4, s[12:15], s36 offen lds
    s_mov_b32 m0, 58368
    s_add_u32 s36, s39, 466944
    buffer_load_dwordx4 v4, s[12:15], s36 offen lds
    s_mov_b32 m0, 59392
    s_add_u32 s36, s39, 475136
    buffer_load_dwordx4 v4, s[12:15], s36 offen lds
    s_mov_b32 m0, 60416
    s_add_u32 s36, s39, 483328
    buffer_load_dwordx4 v4, s[12:15], s36 offen lds
    s_mov_b32 m0, 61440
    s_add_u32 s36, s39, 491520
    buffer_load_dwordx4 v4, s[12:15], s36 offen lds
    s_mov_b32 m0, 62464
    s_add_u32 s36, s39, 499712
    buffer_load_dwordx4 v4, s[12:15], s36 offen lds
    s_mov_b32 m0, 63488
    s_add_u32 s36, s39, 507904
    buffer_load_dwordx4 v4, s[12:15], s36 offen lds
    s_mov_b32 m0, 64512
    s_add_u32 s36, s39, 516096
    buffer_load_dwordx4 v4, s[12:15], s36 offen lds
    s_load_dwordx4 s[52:55], s[0:1], 32
    s_load_dwordx2 s[56:57], s[0:1], 48
    s_waitcnt lgkmcnt(0)
    s_mov_b32 s60, s52
    s_and_b32 s61, s53, 0xffff
    s_mov_b32 s62, 1409024
    s_mov_b32 s63, 0x00020000
    s_mul_i32 s36, s2, 5504
    s_mov_b32 m0, 149760
    s_add_u32 s37, s36, 0
    buffer_load_dwordx4 v6, s[60:63], s37 offen lds
    s_mov_b32 m0, 150784
    s_add_u32 s37, s36, 1024
    buffer_load_dwordx4 v6, s[60:63], s37 offen lds
    s_mov_b32 m0, 149760
    s_add_u32 s37, s36, 2048
    buffer_load_dwordx4 v6, s[60:63], s37 offen lds
    s_mov_b32 m0, 150784
    s_add_u32 s37, s36, 3072
    buffer_load_dwordx4 v6, s[60:63], s37 offen lds
    s_mov_b32 m0, 149760
    s_add_u32 s37, s36, 4096
    buffer_load_dwordx4 v6, s[60:63], s37 offen lds
    s_mov_b32 m0, 150784
    s_add_u32 s37, s36, 5120
    buffer_load_dwordx4 v6, s[60:63], s37 offen lds
    s_mov_b32 s60, s54
    s_and_b32 s61, s55, 0xffff
    s_mov_b32 s62, 1409024
    s_mov_b32 s63, 0x00020000
    s_mul_i32 s36, s2, 5504
    s_mov_b32 m0, 149760
    s_add_u32 s37, s36, 0
    buffer_load_dwordx4 v6, s[60:63], s37 offen lds
    s_mov_b32 m0, 150784
    s_add_u32 s37, s36, 1024
    buffer_load_dwordx4 v6, s[60:63], s37 offen lds
    s_mov_b32 m0, 149760
    s_add_u32 s37, s36, 2048
    buffer_load_dwordx4 v6, s[60:63], s37 offen lds
    s_mov_b32 m0, 150784
    s_add_u32 s37, s36, 3072
    buffer_load_dwordx4 v6, s[60:63], s37 offen lds
    s_mov_b32 m0, 149760
    s_add_u32 s37, s36, 4096
    buffer_load_dwordx4 v6, s[60:63], s37 offen lds
    s_mov_b32 m0, 150784
    s_add_u32 s37, s36, 5120
    buffer_load_dwordx4 v6, s[60:63], s37 offen lds
    s_mov_b32 s60, s56
    s_and_b32 s61, s57, 0xffff
    s_mov_b32 s62, 1409024
    s_mov_b32 s63, 0x00020000
    s_mul_i32 s36, s2, 5504
    s_mov_b32 m0, 149760
    s_add_u32 s37, s36, 0
    buffer_load_dwordx4 v6, s[60:63], s37 offen lds
    s_mov_b32 m0, 150784
    s_add_u32 s37, s36, 1024
    buffer_load_dwordx4 v6, s[60:63], s37 offen lds
    s_mov_b32 m0, 149760
    s_add_u32 s37, s36, 2048
    buffer_load_dwordx4 v6, s[60:63], s37 offen lds
    s_mov_b32 m0, 150784
    s_add_u32 s37, s36, 3072
    buffer_load_dwordx4 v6, s[60:63], s37 offen lds
    s_mov_b32 m0, 149760
    s_add_u32 s37, s36, 4096
    buffer_load_dwordx4 v6, s[60:63], s37 offen lds
    s_mov_b32 m0, 150784
    s_add_u32 s37, s36, 5120
    buffer_load_dwordx4 v6, s[60:63], s37 offen lds
    s_waitcnt vmcnt(18)
    s_barrier
    s_endpgm
k2_compute:
    v_add_u32 v10, s35, v2
    v_lshlrev_b32 v10, 10, v10
    v_lshl_add_u32 v10, v3, 3, v10
    s_lshl_b32 s40, s31, 7
    s_lshl_b32 s39, s34, 6
    s_add_u32 s40, s40, s39
    buffer_load_dwordx2 v[20:21], v10, s[8:11], s40 offen offset:0
    buffer_load_dwordx2 v[22:23], v10, s[8:11], s40 offen offset:16
    buffer_load_dwordx2 v[24:25], v10, s[8:11], s40 offen offset:32
    buffer_load_dwordx2 v[26:27], v10, s[8:11], s40 offen offset:48
    v_mov_b32 v12, 0
    v_mov_b32 v13, 0
    v_mov_b32 v14, 149504
    ds_write_b64 v14, v[12:13]
    ds_write_b64 v14, v[12:13] offset:8
    v_and_b32 v12, 15, v1
    v_lshlrev_b32 v7, 5, v12
    v_lshl_add_u32 v7, v3, 4, v7
    s_lshl_b32 s39, s34, 13
    s_add_u32 s39, s39, 132096
    v_add_u32 v7, s39, v7
    v_bfe_u32 v12, v1, 4, 1
    v_cmp_eq_u32 s[44:45], 0, v12
    s_lshl_b32 s39, s34, 9
    s_add_u32 s39, s39, 148480
    v_lshlrev_b32 v8, 4, v3
    v_add_u32 v8, s39, v8
    v_lshrrev_b32 v12, 5, v1
    v_lshlrev_b32 v12, 3, v12
    v_bfe_u32 v13, v1, 2, 2
    v_add_u32 v12, v12, v13
    v_lshlrev_b32 v5, 7, v12
    v_bfe_u32 v12, v1, 4, 1
    v_lshlrev_b32 v12, 1, v12
    v_bfe_u32 v13, v1, 1, 1
    v_add_u32 v12, v12, v13
    s_lshl_b32 s60, s34, 2
    v_add_u32 v12, s60, v12
    v_bfe_u32 v13, v1, 3, 1
    v_lshlrev_b32 v13, 2, v13
    v_xor_b32 v12, v12, v13
    v_lshl_add_u32 v5, v12, 4, v5
    v_and_b32 v12, 1, v1
    v_lshl_add_u32 v5, v12, 3, v5
    s_lshl_b32 s39, s33, 5
    v_add_u32 v9, s39, v2
    v_mul_u32_u24 v9, 1040, v9
    v_lshl_add_u32 v15, v3, 3, v9
    s_lshl_b32 s39, s34, 9
    s_add_u32 s39, s39, 65536
    v_add_u32 v15, s39, v15
    v_lshl_add_u32 v9, v3, 4, v9
    v_add_u32 v9, 65536, v9
    s_lshl_b32 s39, s34, 9
    v_add_u32 v6, s39, v9
    v_add_u32 v16, 0, v7
    v_mov_b32 v17, 149504
    v_cndmask_b32 v224, v17, v16, s[44:45]
    v_add_u32 v16, 512, v7
    v_mov_b32 v17, 149504
    v_cndmask_b32 v225, v16, v17, s[44:45]
    v_add_u32 v16, 1024, v7
    v_mov_b32 v17, 149504
    v_cndmask_b32 v226, v17, v16, s[44:45]
    v_add_u32 v16, 1536, v7
    v_mov_b32 v17, 149504
    v_cndmask_b32 v227, v16, v17, s[44:45]
    v_add_u32 v16, 2048, v7
    v_mov_b32 v17, 149504
    v_cndmask_b32 v228, v17, v16, s[44:45]
    v_add_u32 v16, 2560, v7
    v_mov_b32 v17, 149504
    v_cndmask_b32 v229, v16, v17, s[44:45]
    v_add_u32 v16, 3072, v7
    v_mov_b32 v17, 149504
    v_cndmask_b32 v230, v17, v16, s[44:45]
    v_add_u32 v16, 3584, v7
    v_mov_b32 v17, 149504
    v_cndmask_b32 v231, v16, v17, s[44:45]
    v_add_u32 v16, 4096, v7
    v_mov_b32 v17, 149504
    v_cndmask_b32 v232, v17, v16, s[44:45]
    v_add_u32 v16, 4608, v7
    v_mov_b32 v17, 149504
    v_cndmask_b32 v233, v16, v17, s[44:45]
    v_add_u32 v16, 5120, v7
    v_mov_b32 v17, 149504
    v_cndmask_b32 v234, v17, v16, s[44:45]
    v_add_u32 v16, 5632, v7
    v_mov_b32 v17, 149504
    v_cndmask_b32 v235, v16, v17, s[44:45]
    v_add_u32 v16, 6144, v7
    v_mov_b32 v17, 149504
    v_cndmask_b32 v236, v17, v16, s[44:45]
    v_add_u32 v16, 6656, v7
    v_mov_b32 v17, 149504
    v_cndmask_b32 v237, v16, v17, s[44:45]
    v_add_u32 v16, 7168, v7
    v_mov_b32 v17, 149504
    v_cndmask_b32 v238, v17, v16, s[44:45]
    v_add_u32 v16, 7680, v7
    v_mov_b32 v17, 149504
    v_cndmask_b32 v239, v16, v17, s[44:45]
    s_waitcnt lgkmcnt(0)
    s_barrier
    ds_read_b128 v[32:35], v6 offset:0
    ds_read_b128 v[160:163], v8 offset:0
    ds_read_b128 v[36:39], v6 offset:32
    ds_read_b128 v[164:167], v8 offset:32
    ds_read_b128 v[40:43], v6 offset:64
    ds_read_b128 v[168:171], v8 offset:64
    ds_read_b128 v[44:47], v6 offset:96
    ds_read_b128 v[172:175], v8 offset:96
    ds_read_b128 v[48:51], v6 offset:128
    ds_read_b128 v[176:179], v8 offset:128
    ds_read_b128 v[52:55], v6 offset:160
    ds_read_b128 v[180:183], v8 offset:160
    ds_read_b128 v[56:59], v6 offset:192
    ds_read_b128 v[184:187], v8 offset:192
    ds_read_b128 v[60:63], v6 offset:224
    ds_read_b128 v[188:191], v8 offset:224
    ds_read_b128 v[64:67], v6 offset:256
    ds_read_b128 v[192:195], v8 offset:256
    ds_read_b128 v[68:71], v6 offset:288
    ds_read_b128 v[196:199], v8 offset:288
    ds_read_b128 v[72:75], v6 offset:320
    ds_read_b128 v[200:203], v8 offset:320
    ds_read_b128 v[76:79], v6 offset:352
    ds_read_b128 v[204:207], v8 offset:352
    ds_read_b128 v[80:83], v6 offset:384
    ds_read_b128 v[208:211], v8 offset:384
    ds_read_b128 v[84:87], v6 offset:416
    ds_read_b128 v[212:215], v8 offset:416
    ds_read_b128 v[88:91], v6 offset:448
    ds_read_b128 v[216:219], v8 offset:448
    ds_read_b128 v[92:95], v6 offset:480
    ds_read_b128 v[220:223], v8 offset:480
    ds_read_b128 v[96:99], v224
    ds_read_b128 v[100:103], v225
    ds_read_b128 v[104:107], v226
    ds_read_b128 v[108:111], v227
    ds_read_b128 v[112:115], v228
    ds_read_b128 v[116:119], v229
    ds_read_b128 v[120:123], v230
    ds_read_b128 v[124:127], v231
    ds_read_b128 v[128:131], v232
    ds_read_b128 v[132:135], v233
    ds_read_b128 v[136:139], v234
    ds_read_b128 v[140:143], v235
    ds_read_b128 v[144:147], v236
    ds_read_b128 v[148:151], v237
    ds_read_b128 v[152:155], v238
    ds_read_b128 v[156:159], v239
    v_mov_b32 v240, 0
    v_mov_b32 v241, 0
    v_mov_b32 v242, 0
    v_mov_b32 v243, 0
    v_mov_b32 v244, 0
    v_mov_b32 v245, 0
    v_mov_b32 v246, 0
    v_mov_b32 v247, 0
    v_mov_b32 v248, 0
    v_mov_b32 v249, 0
    v_mov_b32 v250, 0
    v_mov_b32 v251, 0
    v_mov_b32 v252, 0
    v_mov_b32 v253, 0
    v_mov_b32 v254, 0
    v_mov_b32 v255, 0
    s_waitcnt lgkmcnt(15)
    s_waitcnt lgkmcnt(0)
    v_dot2_f32_bf16 v240, v32, v160, v240
    v_dot2_f32_bf16 v241, v36, v164, v241
    v_dot2_f32_bf16 v242, v40, v168, v242
    v_dot2_f32_bf16 v243, v44, v172, v243
    v_dot2_f32_bf16 v244, v48, v176, v244
    v_dot2_f32_bf16 v245, v52, v180, v245
    v_dot2_f32_bf16 v246, v56, v184, v246
    v_dot2_f32_bf16 v247, v60, v188, v247
    v_dot2_f32_bf16 v248, v64, v192, v248
    v_dot2_f32_bf16 v249, v68, v196, v249
    v_dot2_f32_bf16 v250, v72, v200, v250
    v_dot2_f32_bf16 v251, v76, v204, v251
    v_dot2_f32_bf16 v252, v80, v208, v252
    v_dot2_f32_bf16 v253, v84, v212, v253
    v_dot2_f32_bf16 v254, v88, v216, v254
    v_dot2_f32_bf16 v255, v92, v220, v255
    v_dot2_f32_bf16 v240, v33, v161, v240
    v_dot2_f32_bf16 v241, v37, v165, v241
    v_dot2_f32_bf16 v242, v41, v169, v242
    v_dot2_f32_bf16 v243, v45, v173, v243
    v_dot2_f32_bf16 v244, v49, v177, v244
    v_dot2_f32_bf16 v245, v53, v181, v245
    v_dot2_f32_bf16 v246, v57, v185, v246
    v_dot2_f32_bf16 v247, v61, v189, v247
    v_dot2_f32_bf16 v248, v65, v193, v248
    v_dot2_f32_bf16 v249, v69, v197, v249
    v_dot2_f32_bf16 v250, v73, v201, v250
    v_dot2_f32_bf16 v251, v77, v205, v251
    v_dot2_f32_bf16 v252, v81, v209, v252
    v_dot2_f32_bf16 v253, v85, v213, v253
    v_dot2_f32_bf16 v254, v89, v217, v254
    v_dot2_f32_bf16 v255, v93, v221, v255
    v_dot2_f32_bf16 v240, v34, v162, v240
    v_dot2_f32_bf16 v241, v38, v166, v241
    v_dot2_f32_bf16 v242, v42, v170, v242
    v_dot2_f32_bf16 v243, v46, v174, v243
    v_dot2_f32_bf16 v244, v50, v178, v244
    v_dot2_f32_bf16 v245, v54, v182, v245
    v_dot2_f32_bf16 v246, v58, v186, v246
    v_dot2_f32_bf16 v247, v62, v190, v247
    v_dot2_f32_bf16 v248, v66, v194, v248
    v_dot2_f32_bf16 v249, v70, v198, v249
    v_dot2_f32_bf16 v250, v74, v202, v250
    v_dot2_f32_bf16 v251, v78, v206, v251
    v_dot2_f32_bf16 v252, v82, v210, v252
    v_dot2_f32_bf16 v253, v86, v214, v253
    v_dot2_f32_bf16 v254, v90, v218, v254
    v_dot2_f32_bf16 v255, v94, v222, v255
    v_dot2_f32_bf16 v240, v35, v163, v240
    v_dot2_f32_bf16 v241, v39, v167, v241
    v_dot2_f32_bf16 v242, v43, v171, v242
    v_dot2_f32_bf16 v243, v47, v175, v243
    v_dot2_f32_bf16 v244, v51, v179, v244
    v_dot2_f32_bf16 v245, v55, v183, v245
    v_dot2_f32_bf16 v246, v59, v187, v246
    v_dot2_f32_bf16 v247, v63, v191, v247
    v_dot2_f32_bf16 v248, v67, v195, v248
    v_dot2_f32_bf16 v249, v71, v199, v249
    v_dot2_f32_bf16 v250, v75, v203, v250
    v_dot2_f32_bf16 v251, v79, v207, v251
    v_dot2_f32_bf16 v252, v83, v211, v252
    v_dot2_f32_bf16 v253, v87, v215, v253
    v_dot2_f32_bf16 v254, v91, v219, v254
    v_dot2_f32_bf16 v255, v95, v223, v255
    s_nop 2
    v_mfma_f32_32x32x16_bf16 v[160:175], v[96:99], v[32:35], 0
    v_mfma_f32_32x32x16_bf16 v[160:175], v[100:103], v[36:39], v[160:175]
    v_mfma_f32_32x32x16_bf16 v[176:191], v[104:107], v[40:43], 0
    v_mfma_f32_32x32x16_bf16 v[176:191], v[108:111], v[44:47], v[176:191]
    v_mfma_f32_32x32x16_bf16 v[192:207], v[112:115], v[48:51], 0
    v_mfma_f32_32x32x16_bf16 v[192:207], v[116:119], v[52:55], v[192:207]
    v_mfma_f32_32x32x16_bf16 v[208:223], v[120:123], v[56:59], 0
    v_mfma_f32_32x32x16_bf16 v[208:223], v[124:127], v[60:63], v[208:223]
    v_mov_b32 v224, v240
    v_mov_b32 v225, v241
    v_mov_b32 v226, v242
    v_mov_b32 v227, v243
    v_mov_b32 v228, v244
    v_mov_b32 v229, v245
    v_mov_b32 v230, v246
    v_mov_b32 v231, v247
    v_mov_b32 v232, v248
    v_mov_b32 v233, v249
    v_mov_b32 v234, v250
    v_mov_b32 v235, v251
    v_mov_b32 v236, v252
    v_mov_b32 v237, v253
    v_mov_b32 v238, v254
    v_mov_b32 v239, v255
    v_mfma_f32_32x32x16_bf16 v[32:47], v[128:131], v[64:67], 0
    v_mfma_f32_32x32x16_bf16 v[32:47], v[132:135], v[68:71], v[32:47]
    v_mfma_f32_32x32x16_bf16 v[48:63], v[136:139], v[72:75], 0
    v_mfma_f32_32x32x16_bf16 v[48:63], v[140:143], v[76:79], v[48:63]
    v_mfma_f32_32x32x16_bf16 v[96:111], v[144:147], v[80:83], 0
    v_mfma_f32_32x32x16_bf16 v[96:111], v[148:151], v[84:87], v[96:111]
    v_mfma_f32_32x32x16_bf16 v[112:127], v[152:155], v[88:91], 0
    v_mfma_f32_32x32x16_bf16 v[112:127], v[156:159], v[92:95], v[112:127]
    v_permlane32_swap_b32 v240, v224
    v_permlane32_swap_b32 v241, v225
    v_permlane32_swap_b32 v242, v226
    v_permlane32_swap_b32 v243, v227
    v_permlane32_swap_b32 v244, v228
    v_permlane32_swap_b32 v245, v229
    v_permlane32_swap_b32 v246, v230
    v_permlane32_swap_b32 v247, v231
    v_permlane32_swap_b32 v248, v232
    v_permlane32_swap_b32 v249, v233
    v_permlane32_swap_b32 v250, v234
    v_permlane32_swap_b32 v251, v235
    v_permlane32_swap_b32 v252, v236
    v_permlane32_swap_b32 v253, v237
    v_permlane32_swap_b32 v254, v238
    v_permlane32_swap_b32 v255, v239
    v_add_f32 v240, v240, v224
    v_add_f32 v241, v241, v225
    v_add_f32 v242, v242, v226
    v_add_f32 v243, v243, v227
    v_add_f32 v244, v244, v228
    v_add_f32 v245, v245, v229
    v_add_f32 v246, v246, v230
    v_add_f32 v247, v247, v231
    v_add_f32 v248, v248, v232
    v_add_f32 v249, v249, v233
    v_add_f32 v250, v250, v234
    v_add_f32 v251, v251, v235
    v_add_f32 v252, v252, v236
    v_add_f32 v253, v253, v237
    v_add_f32 v254, v254, v238
    v_add_f32 v255, v255, v239
    v_add_f32 v240, 0x358637bd, v240
    v_add_f32 v241, 0x358637bd, v241
    v_add_f32 v242, 0x358637bd, v242
    v_add_f32 v243, 0x358637bd, v243
    v_add_f32 v244, 0x358637bd, v244
    v_add_f32 v245, 0x358637bd, v245
    v_add_f32 v246, 0x358637bd, v246
    v_add_f32 v247, 0x358637bd, v247
    v_add_f32 v248, 0x358637bd, v248
    v_add_f32 v249, 0x358637bd, v249
    v_add_f32 v250, 0x358637bd, v250
    v_add_f32 v251, 0x358637bd, v251
    v_add_f32 v252, 0x358637bd, v252
    v_add_f32 v253, 0x358637bd, v253
    v_add_f32 v254, 0x358637bd, v254
    v_add_f32 v255, 0x358637bd, v255
    v_rcp_f32 v240, v240
    v_rcp_f32 v241, v241
    v_rcp_f32 v242, v242
    v_rcp_f32 v243, v243
    v_rcp_f32 v244, v244
    v_rcp_f32 v245, v245
    v_rcp_f32 v246, v246
    v_rcp_f32 v247, v247
    v_rcp_f32 v248, v248
    v_rcp_f32 v249, v249
    v_rcp_f32 v250, v250
    v_rcp_f32 v251, v251
    v_rcp_f32 v252, v252
    v_rcp_f32 v253, v253
    v_rcp_f32 v254, v254
    v_rcp_f32 v255, v255
    s_nop 7
    v_mul_f32 v160, v160, v240
    v_mul_f32 v161, v161, v240
    v_mul_f32 v162, v162, v240
    v_mul_f32 v163, v163, v240
    v_mul_f32 v164, v164, v240
    v_mul_f32 v165, v165, v240
    v_mul_f32 v166, v166, v240
    v_mul_f32 v167, v167, v240
    v_mul_f32 v168, v168, v241
    v_mul_f32 v169, v169, v241
    v_mul_f32 v170, v170, v241
    v_mul_f32 v171, v171, v241
    v_mul_f32 v172, v172, v241
    v_mul_f32 v173, v173, v241
    v_mul_f32 v174, v174, v241
    v_mul_f32 v175, v175, v241
    v_cvt_pk_bf16_f32 v160, v160, v161
    v_cvt_pk_bf16_f32 v161, v162, v163
    v_cvt_pk_bf16_f32 v162, v164, v165
    v_cvt_pk_bf16_f32 v163, v166, v167
    v_cvt_pk_bf16_f32 v164, v168, v169
    v_cvt_pk_bf16_f32 v165, v170, v171
    v_cvt_pk_bf16_f32 v166, v172, v173
    v_cvt_pk_bf16_f32 v167, v174, v175
    ds_write_b64 v15, v[160:161] offset:0
    ds_write_b64 v15, v[162:163] offset:16
    ds_write_b64 v15, v[164:165] offset:32
    ds_write_b64 v15, v[166:167] offset:48
    v_mul_f32 v176, v176, v242
    v_mul_f32 v177, v177, v242
    v_mul_f32 v178, v178, v242
    v_mul_f32 v179, v179, v242
    v_mul_f32 v180, v180, v242
    v_mul_f32 v181, v181, v242
    v_mul_f32 v182, v182, v242
    v_mul_f32 v183, v183, v242
    v_mul_f32 v184, v184, v243
    v_mul_f32 v185, v185, v243
    v_mul_f32 v186, v186, v243
    v_mul_f32 v187, v187, v243
    v_mul_f32 v188, v188, v243
    v_mul_f32 v189, v189, v243
    v_mul_f32 v190, v190, v243
    v_mul_f32 v191, v191, v243
    v_cvt_pk_bf16_f32 v176, v176, v177
    v_cvt_pk_bf16_f32 v177, v178, v179
    v_cvt_pk_bf16_f32 v178, v180, v181
    v_cvt_pk_bf16_f32 v179, v182, v183
    v_cvt_pk_bf16_f32 v180, v184, v185
    v_cvt_pk_bf16_f32 v181, v186, v187
    v_cvt_pk_bf16_f32 v182, v188, v189
    v_cvt_pk_bf16_f32 v183, v190, v191
    ds_write_b64 v15, v[176:177] offset:64
    ds_write_b64 v15, v[178:179] offset:80
    ds_write_b64 v15, v[180:181] offset:96
    ds_write_b64 v15, v[182:183] offset:112
    v_mul_f32 v192, v192, v244
    v_mul_f32 v193, v193, v244
    v_mul_f32 v194, v194, v244
    v_mul_f32 v195, v195, v244
    v_mul_f32 v196, v196, v244
    v_mul_f32 v197, v197, v244
    v_mul_f32 v198, v198, v244
    v_mul_f32 v199, v199, v244
    v_mul_f32 v200, v200, v245
    v_mul_f32 v201, v201, v245
    v_mul_f32 v202, v202, v245
    v_mul_f32 v203, v203, v245
    v_mul_f32 v204, v204, v245
    v_mul_f32 v205, v205, v245
    v_mul_f32 v206, v206, v245
    v_mul_f32 v207, v207, v245
    v_cvt_pk_bf16_f32 v192, v192, v193
    v_cvt_pk_bf16_f32 v193, v194, v195
    v_cvt_pk_bf16_f32 v194, v196, v197
    v_cvt_pk_bf16_f32 v195, v198, v199
    v_cvt_pk_bf16_f32 v196, v200, v201
    v_cvt_pk_bf16_f32 v197, v202, v203
    v_cvt_pk_bf16_f32 v198, v204, v205
    v_cvt_pk_bf16_f32 v199, v206, v207
    ds_write_b64 v15, v[192:193] offset:128
    ds_write_b64 v15, v[194:195] offset:144
    ds_write_b64 v15, v[196:197] offset:160
    ds_write_b64 v15, v[198:199] offset:176
    v_mul_f32 v208, v208, v246
    v_mul_f32 v209, v209, v246
    v_mul_f32 v210, v210, v246
    v_mul_f32 v211, v211, v246
    v_mul_f32 v212, v212, v246
    v_mul_f32 v213, v213, v246
    v_mul_f32 v214, v214, v246
    v_mul_f32 v215, v215, v246
    v_mul_f32 v216, v216, v247
    v_mul_f32 v217, v217, v247
    v_mul_f32 v218, v218, v247
    v_mul_f32 v219, v219, v247
    v_mul_f32 v220, v220, v247
    v_mul_f32 v221, v221, v247
    v_mul_f32 v222, v222, v247
    v_mul_f32 v223, v223, v247
    v_cvt_pk_bf16_f32 v208, v208, v209
    v_cvt_pk_bf16_f32 v209, v210, v211
    v_cvt_pk_bf16_f32 v210, v212, v213
    v_cvt_pk_bf16_f32 v211, v214, v215
    v_cvt_pk_bf16_f32 v212, v216, v217
    v_cvt_pk_bf16_f32 v213, v218, v219
    v_cvt_pk_bf16_f32 v214, v220, v221
    v_cvt_pk_bf16_f32 v215, v222, v223
    ds_write_b64 v15, v[208:209] offset:192
    ds_write_b64 v15, v[210:211] offset:208
    ds_write_b64 v15, v[212:213] offset:224
    ds_write_b64 v15, v[214:215] offset:240
    v_mul_f32 v32, v32, v248
    v_mul_f32 v33, v33, v248
    v_mul_f32 v34, v34, v248
    v_mul_f32 v35, v35, v248
    v_mul_f32 v36, v36, v248
    v_mul_f32 v37, v37, v248
    v_mul_f32 v38, v38, v248
    v_mul_f32 v39, v39, v248
    v_mul_f32 v40, v40, v249
    v_mul_f32 v41, v41, v249
    v_mul_f32 v42, v42, v249
    v_mul_f32 v43, v43, v249
    v_mul_f32 v44, v44, v249
    v_mul_f32 v45, v45, v249
    v_mul_f32 v46, v46, v249
    v_mul_f32 v47, v47, v249
    v_cvt_pk_bf16_f32 v32, v32, v33
    v_cvt_pk_bf16_f32 v33, v34, v35
    v_cvt_pk_bf16_f32 v34, v36, v37
    v_cvt_pk_bf16_f32 v35, v38, v39
    v_cvt_pk_bf16_f32 v36, v40, v41
    v_cvt_pk_bf16_f32 v37, v42, v43
    v_cvt_pk_bf16_f32 v38, v44, v45
    v_cvt_pk_bf16_f32 v39, v46, v47
    ds_write_b64 v15, v[32:33] offset:256
    ds_write_b64 v15, v[34:35] offset:272
    ds_write_b64 v15, v[36:37] offset:288
    ds_write_b64 v15, v[38:39] offset:304
    v_mul_f32 v48, v48, v250
    v_mul_f32 v49, v49, v250
    v_mul_f32 v50, v50, v250
    v_mul_f32 v51, v51, v250
    v_mul_f32 v52, v52, v250
    v_mul_f32 v53, v53, v250
    v_mul_f32 v54, v54, v250
    v_mul_f32 v55, v55, v250
    v_mul_f32 v56, v56, v251
    v_mul_f32 v57, v57, v251
    v_mul_f32 v58, v58, v251
    v_mul_f32 v59, v59, v251
    v_mul_f32 v60, v60, v251
    v_mul_f32 v61, v61, v251
    v_mul_f32 v62, v62, v251
    v_mul_f32 v63, v63, v251
    v_cvt_pk_bf16_f32 v48, v48, v49
    v_cvt_pk_bf16_f32 v49, v50, v51
    v_cvt_pk_bf16_f32 v50, v52, v53
    v_cvt_pk_bf16_f32 v51, v54, v55
    v_cvt_pk_bf16_f32 v52, v56, v57
    v_cvt_pk_bf16_f32 v53, v58, v59
    v_cvt_pk_bf16_f32 v54, v60, v61
    v_cvt_pk_bf16_f32 v55, v62, v63
    ds_write_b64 v15, v[48:49] offset:320
    ds_write_b64 v15, v[50:51] offset:336
    ds_write_b64 v15, v[52:53] offset:352
    ds_write_b64 v15, v[54:55] offset:368
    v_mul_f32 v96, v96, v252
    v_mul_f32 v97, v97, v252
    v_mul_f32 v98, v98, v252
    v_mul_f32 v99, v99, v252
    v_mul_f32 v100, v100, v252
    v_mul_f32 v101, v101, v252
    v_mul_f32 v102, v102, v252
    v_mul_f32 v103, v103, v252
    v_mul_f32 v104, v104, v253
    v_mul_f32 v105, v105, v253
    v_mul_f32 v106, v106, v253
    v_mul_f32 v107, v107, v253
    v_mul_f32 v108, v108, v253
    v_mul_f32 v109, v109, v253
    v_mul_f32 v110, v110, v253
    v_mul_f32 v111, v111, v253
    v_cvt_pk_bf16_f32 v96, v96, v97
    v_cvt_pk_bf16_f32 v97, v98, v99
    v_cvt_pk_bf16_f32 v98, v100, v101
    v_cvt_pk_bf16_f32 v99, v102, v103
    v_cvt_pk_bf16_f32 v100, v104, v105
    v_cvt_pk_bf16_f32 v101, v106, v107
    v_cvt_pk_bf16_f32 v102, v108, v109
    v_cvt_pk_bf16_f32 v103, v110, v111
    ds_write_b64 v15, v[96:97] offset:384
    ds_write_b64 v15, v[98:99] offset:400
    ds_write_b64 v15, v[100:101] offset:416
    ds_write_b64 v15, v[102:103] offset:432
    v_mul_f32 v112, v112, v254
    v_mul_f32 v113, v113, v254
    v_mul_f32 v114, v114, v254
    v_mul_f32 v115, v115, v254
    v_mul_f32 v116, v116, v254
    v_mul_f32 v117, v117, v254
    v_mul_f32 v118, v118, v254
    v_mul_f32 v119, v119, v254
    v_mul_f32 v120, v120, v255
    v_mul_f32 v121, v121, v255
    v_mul_f32 v122, v122, v255
    v_mul_f32 v123, v123, v255
    v_mul_f32 v124, v124, v255
    v_mul_f32 v125, v125, v255
    v_mul_f32 v126, v126, v255
    v_mul_f32 v127, v127, v255
    v_cvt_pk_bf16_f32 v112, v112, v113
    v_cvt_pk_bf16_f32 v113, v114, v115
    v_cvt_pk_bf16_f32 v114, v116, v117
    v_cvt_pk_bf16_f32 v115, v118, v119
    v_cvt_pk_bf16_f32 v116, v120, v121
    v_cvt_pk_bf16_f32 v117, v122, v123
    v_cvt_pk_bf16_f32 v118, v124, v125
    v_cvt_pk_bf16_f32 v119, v126, v127
    ds_write_b64 v15, v[112:113] offset:448
    ds_write_b64 v15, v[114:115] offset:464
    ds_write_b64 v15, v[116:117] offset:480
    ds_write_b64 v15, v[118:119] offset:496
    s_waitcnt vmcnt(0) lgkmcnt(0)
    s_barrier
    v_mov_b32 v224, 0
    v_mov_b32 v225, 0
    v_mov_b32 v226, 0
    v_mov_b32 v227, 0
    v_mov_b32 v228, 0
    v_mov_b32 v229, 0
    v_mov_b32 v230, 0
    v_mov_b32 v231, 0
    v_mov_b32 v232, 0
    v_mov_b32 v233, 0
    v_mov_b32 v234, 0
    v_mov_b32 v235, 0
    v_mov_b32 v236, 0
    v_mov_b32 v237, 0
    v_mov_b32 v238, 0
    v_mov_b32 v239, 0
    ds_read_b64_tr_b16 v[32:33], v5 offset:0
    ds_read_b64_tr_b16 v[34:35], v5 offset:512
    ds_read_b128 v[40:43], v9 offset:0
    ds_read_b64_tr_b16 v[36:37], v5 offset:2048
    ds_read_b64_tr_b16 v[38:39], v5 offset:2560
    ds_read_b128 v[44:47], v9 offset:32
    s_waitcnt lgkmcnt(3)
    v_mfma_f32_32x32x16_bf16 v[224:239], v[32:35], v[40:43], v[224:239]
    ds_read_b64_tr_b16 v[32:33], v5 offset:4096
    ds_read_b64_tr_b16 v[34:35], v5 offset:4608
    ds_read_b128 v[40:43], v9 offset:64
    s_waitcnt lgkmcnt(3)
    v_mfma_f32_32x32x16_bf16 v[224:239], v[36:39], v[44:47], v[224:239]
    ds_read_b64_tr_b16 v[36:37], v5 offset:6144
    ds_read_b64_tr_b16 v[38:39], v5 offset:6656
    ds_read_b128 v[44:47], v9 offset:96
    s_waitcnt lgkmcnt(3)
    v_mfma_f32_32x32x16_bf16 v[224:239], v[32:35], v[40:43], v[224:239]
    ds_read_b64_tr_b16 v[32:33], v5 offset:8192
    ds_read_b64_tr_b16 v[34:35], v5 offset:8704
    ds_read_b128 v[40:43], v9 offset:128
    s_waitcnt lgkmcnt(3)
    v_mfma_f32_32x32x16_bf16 v[224:239], v[36:39], v[44:47], v[224:239]
    ds_read_b64_tr_b16 v[36:37], v5 offset:10240
    ds_read_b64_tr_b16 v[38:39], v5 offset:10752
    ds_read_b128 v[44:47], v9 offset:160
    s_waitcnt lgkmcnt(3)
    v_mfma_f32_32x32x16_bf16 v[224:239], v[32:35], v[40:43], v[224:239]
    ds_read_b64_tr_b16 v[32:33], v5 offset:12288
    ds_read_b64_tr_b16 v[34:35], v5 offset:12800
    ds_read_b128 v[40:43], v9 offset:192
    s_waitcnt lgkmcnt(3)
    v_mfma_f32_32x32x16_bf16 v[224:239], v[36:39], v[44:47], v[224:239]
    ds_read_b64_tr_b16 v[36:37], v5 offset:14336
    ds_read_b64_tr_b16 v[38:39], v5 offset:14848
    ds_read_b128 v[44:47], v9 offset:224
    s_waitcnt lgkmcnt(3)
    v_mfma_f32_32x32x16_bf16 v[224:239], v[32:35], v[40:43], v[224:239]
    ds_read_b64_tr_b16 v[32:33], v5 offset:16384
    ds_read_b64_tr_b16 v[34:35], v5 offset:16896
    ds_read_b128 v[40:43], v9 offset:256
    s_waitcnt lgkmcnt(3)
    v_mfma_f32_32x32x16_bf16 v[224:239], v[36:39], v[44:47], v[224:239]
    ds_read_b64_tr_b16 v[36:37], v5 offset:18432
    ds_read_b64_tr_b16 v[38:39], v5 offset:18944
    ds_read_b128 v[44:47], v9 offset:288
    s_waitcnt lgkmcnt(3)
    v_mfma_f32_32x32x16_bf16 v[224:239], v[32:35], v[40:43], v[224:239]
    ds_read_b64_tr_b16 v[32:33], v5 offset:20480
    ds_read_b64_tr_b16 v[34:35], v5 offset:20992
    ds_read_b128 v[40:43], v9 offset:320
    s_waitcnt lgkmcnt(3)
    v_mfma_f32_32x32x16_bf16 v[224:239], v[36:39], v[44:47], v[224:239]
    ds_read_b64_tr_b16 v[36:37], v5 offset:22528
    ds_read_b64_tr_b16 v[38:39], v5 offset:23040
    ds_read_b128 v[44:47], v9 offset:352
    s_waitcnt lgkmcnt(3)
    v_mfma_f32_32x32x16_bf16 v[224:239], v[32:35], v[40:43], v[224:239]
    ds_read_b64_tr_b16 v[32:33], v5 offset:24576
    ds_read_b64_tr_b16 v[34:35], v5 offset:25088
    ds_read_b128 v[40:43], v9 offset:384
    s_waitcnt lgkmcnt(3)
    v_mfma_f32_32x32x16_bf16 v[224:239], v[36:39], v[44:47], v[224:239]
    ds_read_b64_tr_b16 v[36:37], v5 offset:26624
    ds_read_b64_tr_b16 v[38:39], v5 offset:27136
    ds_read_b128 v[44:47], v9 offset:416
    s_waitcnt lgkmcnt(3)
    v_mfma_f32_32x32x16_bf16 v[224:239], v[32:35], v[40:43], v[224:239]
    ds_read_b64_tr_b16 v[32:33], v5 offset:28672
    ds_read_b64_tr_b16 v[34:35], v5 offset:29184
    ds_read_b128 v[40:43], v9 offset:448
    s_waitcnt lgkmcnt(3)
    v_mfma_f32_32x32x16_bf16 v[224:239], v[36:39], v[44:47], v[224:239]
    ds_read_b64_tr_b16 v[36:37], v5 offset:30720
    ds_read_b64_tr_b16 v[38:39], v5 offset:31232
    ds_read_b128 v[44:47], v9 offset:480
    s_waitcnt lgkmcnt(3)
    v_mfma_f32_32x32x16_bf16 v[224:239], v[32:35], v[40:43], v[224:239]
    ds_read_b64_tr_b16 v[32:33], v5 offset:32768
    ds_read_b64_tr_b16 v[34:35], v5 offset:33280
    ds_read_b128 v[40:43], v9 offset:512
    s_waitcnt lgkmcnt(3)
    v_mfma_f32_32x32x16_bf16 v[224:239], v[36:39], v[44:47], v[224:239]
    ds_read_b64_tr_b16 v[36:37], v5 offset:34816
    ds_read_b64_tr_b16 v[38:39], v5 offset:35328
    ds_read_b128 v[44:47], v9 offset:544
    s_waitcnt lgkmcnt(3)
    v_mfma_f32_32x32x16_bf16 v[224:239], v[32:35], v[40:43], v[224:239]
    ds_read_b64_tr_b16 v[32:33], v5 offset:36864
    ds_read_b64_tr_b16 v[34:35], v5 offset:37376
    ds_read_b128 v[40:43], v9 offset:576
    s_waitcnt lgkmcnt(3)
    v_mfma_f32_32x32x16_bf16 v[224:239], v[36:39], v[44:47], v[224:239]
    ds_read_b64_tr_b16 v[36:37], v5 offset:38912
    ds_read_b64_tr_b16 v[38:39], v5 offset:39424
    ds_read_b128 v[44:47], v9 offset:608
    s_waitcnt lgkmcnt(3)
    v_mfma_f32_32x32x16_bf16 v[224:239], v[32:35], v[40:43], v[224:239]
    ds_read_b64_tr_b16 v[32:33], v5 offset:40960
    ds_read_b64_tr_b16 v[34:35], v5 offset:41472
    ds_read_b128 v[40:43], v9 offset:640
    s_waitcnt lgkmcnt(3)
    v_mfma_f32_32x32x16_bf16 v[224:239], v[36:39], v[44:47], v[224:239]
    ds_read_b64_tr_b16 v[36:37], v5 offset:43008
    ds_read_b64_tr_b16 v[38:39], v5 offset:43520
    ds_read_b128 v[44:47], v9 offset:672
    s_waitcnt lgkmcnt(3)
    v_mfma_f32_32x32x16_bf16 v[224:239], v[32:35], v[40:43], v[224:239]
    ds_read_b64_tr_b16 v[32:33], v5 offset:45056
    ds_read_b64_tr_b16 v[34:35], v5 offset:45568
    ds_read_b128 v[40:43], v9 offset:704
    s_waitcnt lgkmcnt(3)
    v_mfma_f32_32x32x16_bf16 v[224:239], v[36:39], v[44:47], v[224:239]
    ds_read_b64_tr_b16 v[36:37], v5 offset:47104
    ds_read_b64_tr_b16 v[38:39], v5 offset:47616
    ds_read_b128 v[44:47], v9 offset:736
    s_waitcnt lgkmcnt(3)
    v_mfma_f32_32x32x16_bf16 v[224:239], v[32:35], v[40:43], v[224:239]
    ds_read_b64_tr_b16 v[32:33], v5 offset:49152
    ds_read_b64_tr_b16 v[34:35], v5 offset:49664
    ds_read_b128 v[40:43], v9 offset:768
    s_waitcnt lgkmcnt(3)
    v_mfma_f32_32x32x16_bf16 v[224:239], v[36:39], v[44:47], v[224:239]
    ds_read_b64_tr_b16 v[36:37], v5 offset:51200
    ds_read_b64_tr_b16 v[38:39], v5 offset:51712
    ds_read_b128 v[44:47], v9 offset:800
    s_waitcnt lgkmcnt(3)
    v_mfma_f32_32x32x16_bf16 v[224:239], v[32:35], v[40:43], v[224:239]
    ds_read_b64_tr_b16 v[32:33], v5 offset:53248
    ds_read_b64_tr_b16 v[34:35], v5 offset:53760
    ds_read_b128 v[40:43], v9 offset:832
    s_waitcnt lgkmcnt(3)
    v_mfma_f32_32x32x16_bf16 v[224:239], v[36:39], v[44:47], v[224:239]
    ds_read_b64_tr_b16 v[36:37], v5 offset:55296
    ds_read_b64_tr_b16 v[38:39], v5 offset:55808
    ds_read_b128 v[44:47], v9 offset:864
    s_waitcnt lgkmcnt(3)
    v_mfma_f32_32x32x16_bf16 v[224:239], v[32:35], v[40:43], v[224:239]
    ds_read_b64_tr_b16 v[32:33], v5 offset:57344
    ds_read_b64_tr_b16 v[34:35], v5 offset:57856
    ds_read_b128 v[40:43], v9 offset:896
    s_waitcnt lgkmcnt(3)
    v_mfma_f32_32x32x16_bf16 v[224:239], v[36:39], v[44:47], v[224:239]
    ds_read_b64_tr_b16 v[36:37], v5 offset:59392
    ds_read_b64_tr_b16 v[38:39], v5 offset:59904
    ds_read_b128 v[44:47], v9 offset:928
    s_waitcnt lgkmcnt(3)
    v_mfma_f32_32x32x16_bf16 v[224:239], v[32:35], v[40:43], v[224:239]
    ds_read_b64_tr_b16 v[32:33], v5 offset:61440
    ds_read_b64_tr_b16 v[34:35], v5 offset:61952
    ds_read_b128 v[40:43], v9 offset:960
    s_waitcnt lgkmcnt(3)
    v_mfma_f32_32x32x16_bf16 v[224:239], v[36:39], v[44:47], v[224:239]
    ds_read_b64_tr_b16 v[36:37], v5 offset:63488
    ds_read_b64_tr_b16 v[38:39], v5 offset:64000
    ds_read_b128 v[44:47], v9 offset:992
    s_waitcnt lgkmcnt(3)
    v_mfma_f32_32x32x16_bf16 v[224:239], v[32:35], v[40:43], v[224:239]
    s_waitcnt lgkmcnt(0)
    v_mfma_f32_32x32x16_bf16 v[224:239], v[36:39], v[44:47], v[224:239]
    s_nop 15
    v_cvt_pk_bf16_f32 v48, v224, v225
    v_cvt_pk_bf16_f32 v49, v226, v227
    v_cvt_pk_bf16_f32 v50, v228, v229
    v_cvt_pk_bf16_f32 v51, v230, v231
    v_cvt_pk_bf16_f32 v52, v232, v233
    v_cvt_pk_bf16_f32 v53, v234, v235
    v_cvt_pk_bf16_f32 v54, v236, v237
    v_cvt_pk_bf16_f32 v55, v238, v239
    v_lshlrev_b32 v224, 16, v48
    v_and_b32 v225, 0xffff0000, v48
    v_lshlrev_b32 v56, 16, v20
    v_and_b32 v57, 0xffff0000, v20
    v_lshlrev_b32 v226, 16, v49
    v_and_b32 v227, 0xffff0000, v49
    v_lshlrev_b32 v58, 16, v21
    v_and_b32 v59, 0xffff0000, v21
    v_lshlrev_b32 v228, 16, v50
    v_and_b32 v229, 0xffff0000, v50
    v_lshlrev_b32 v60, 16, v22
    v_and_b32 v61, 0xffff0000, v22
    v_lshlrev_b32 v230, 16, v51
    v_and_b32 v231, 0xffff0000, v51
    v_lshlrev_b32 v62, 16, v23
    v_and_b32 v63, 0xffff0000, v23
    v_lshlrev_b32 v232, 16, v52
    v_and_b32 v233, 0xffff0000, v52
    v_lshlrev_b32 v64, 16, v24
    v_and_b32 v65, 0xffff0000, v24
    v_lshlrev_b32 v234, 16, v53
    v_and_b32 v235, 0xffff0000, v53
    v_lshlrev_b32 v66, 16, v25
    v_and_b32 v67, 0xffff0000, v25
    v_lshlrev_b32 v236, 16, v54
    v_and_b32 v237, 0xffff0000, v54
    v_lshlrev_b32 v68, 16, v26
    v_and_b32 v69, 0xffff0000, v26
    v_lshlrev_b32 v238, 16, v55
    v_and_b32 v239, 0xffff0000, v55
    v_lshlrev_b32 v70, 16, v27
    v_and_b32 v71, 0xffff0000, v27
    v_add_f32 v224, v224, v56
    v_add_f32 v225, v225, v57
    v_add_f32 v226, v226, v58
    v_add_f32 v227, v227, v59
    v_add_f32 v228, v228, v60
    v_add_f32 v229, v229, v61
    v_add_f32 v230, v230, v62
    v_add_f32 v231, v231, v63
    v_add_f32 v232, v232, v64
    v_add_f32 v233, v233, v65
    v_add_f32 v234, v234, v66
    v_add_f32 v235, v235, v67
    v_add_f32 v236, v236, v68
    v_add_f32 v237, v237, v69
    v_add_f32 v238, v238, v70
    v_add_f32 v239, v239, v71
    v_cvt_pk_bf16_f32 v48, v224, v225
    v_cvt_pk_bf16_f32 v49, v226, v227
    v_cvt_pk_bf16_f32 v50, v228, v229
    v_cvt_pk_bf16_f32 v51, v230, v231
    v_cvt_pk_bf16_f32 v52, v232, v233
    v_cvt_pk_bf16_f32 v53, v234, v235
    v_cvt_pk_bf16_f32 v54, v236, v237
    v_cvt_pk_bf16_f32 v55, v238, v239
    s_add_u32 s40, s40, 2097152
    v_lshl_add_u32 v10, v3, 3, v10
    s_nop 0
    v_permlane32_swap_b32 v48, v50
    v_permlane32_swap_b32 v49, v51
    v_permlane32_swap_b32 v52, v54
    v_permlane32_swap_b32 v53, v55
    buffer_store_dwordx4 v[48:51], v10, s[16:19], s40 offen offset:0
    buffer_store_dwordx4 v[52:55], v10, s[16:19], s40 offen offset:32
    v_mov_b32 v72, 0
    v_mov_b32 v73, 0
    v_mov_b32 v74, 0x3f803f80
    v_dot2_f32_bf16 v72, v48, v74, v72
    v_dot2_f32_bf16 v72, v49, v74, v72
    v_dot2_f32_bf16 v72, v50, v74, v72
    v_dot2_f32_bf16 v72, v51, v74, v72
    v_dot2_f32_bf16 v72, v52, v74, v72
    v_dot2_f32_bf16 v72, v53, v74, v72
    v_dot2_f32_bf16 v72, v54, v74, v72
    v_dot2_f32_bf16 v72, v55, v74, v72
    v_dot2_f32_bf16 v73, v48, v48, v73
    v_dot2_f32_bf16 v73, v49, v49, v73
    v_dot2_f32_bf16 v73, v50, v50, v73
    v_dot2_f32_bf16 v73, v51, v51, v73
    v_dot2_f32_bf16 v73, v52, v52, v73
    v_dot2_f32_bf16 v73, v53, v53, v73
    v_dot2_f32_bf16 v73, v54, v54, v73
    v_dot2_f32_bf16 v73, v55, v55, v73
    s_nop 3
    v_mov_b32 v12, v72
    s_nop 1
    v_permlane32_swap_b32 v72, v12
    s_nop 0
    v_add_f32 v72, v72, v12
    v_mov_b32 v12, v73
    s_nop 1
    v_permlane32_swap_b32 v73, v12
    s_nop 0
    v_add_f32 v73, v73, v12
    v_add_u32 v12, s35, v2
    v_lshlrev_b32 v12, 7, v12
    s_lshl_b32 s39, s31, 4
    s_lshl_b32 s41, s34, 3
    s_add_u32 s39, s39, s41
    s_add_u32 s39, s39, 13631488
    v_cmp_gt_u32 vcc, 32, v1
    s_and_saveexec_b64 s[42:43], vcc
    buffer_store_dwordx2 v[72:73], v12, s[16:19], s39 offen
    s_mov_b64 exec, s[42:43]
k2_end:
    s_endpgm
.globl k3_kernel
.p2align 8
.type k3_kernel,@function
k3_kernel:
    s_cmp_ge_u32 s2, 240
    s_cbranch_scc1 k3_end
    s_load_dwordx4 s[4:7], s[0:1], 32
    s_load_dwordx2 s[26:27], s[0:1], 72
    s_and_b32 s28, s2, 7
    s_lshr_b32 s29, s2, 3
    s_lshl_b32 s30, s28, 1
    s_and_b32 s31, s29, 1
    s_add_u32 s30, s30, s31
    s_lshr_b32 s31, s29, 1
    v_and_b32 v1, 63, v0
    v_lshrrev_b32 v8, 6, v0
    v_and_b32 v2, 31, v1
    v_lshrrev_b32 v3, 5, v1
    v_readfirstlane_b32 s32, v8
    s_waitcnt lgkmcnt(0)
    s_mov_b32 s8, s4
    s_and_b32 s9, s5, 0xffff
    s_mov_b32 s10, 1409024
    s_mov_b32 s11, 0x00020000
    s_mov_b32 s12, s6
    s_and_b32 s13, s7, 0xffff
    s_mov_b32 s14, 1409024
    s_mov_b32 s15, 0x00020000
    s_mov_b32 s16, s26
    s_and_b32 s17, s27, 0xffff
    s_mov_b32 s18, 16777216
    s_mov_b32 s19, 0x00020000
    s_lshl_b32 s33, s30, 7
    s_lshl_b32 s34, s32, 5
    s_add_u32 s47, s33, s34
    s_cmp_lg_u32 s32, 4
    s_cbranch_scc1 k3_compute
    v_lshrrev_b32 v8, 3, v1
    v_mul_u32_u24 v4, 1024, v8
    v_lshrrev_b32 v8, 4, v1
    v_and_b32 v9, 7, v1
    v_xor_b32 v9, v9, v8
    v_lshl_add_u32 v4, v9, 4, v4
    v_xor_b32 v5, 64, v4
    v_mul_u32_u24 v8, 43, v1
    v_lshrrev_b32 v8, 9, v8
    v_mul_u32_u24 v9, 12, v8
    v_sub_u32 v9, v1, v9
    v_mul_u32_u24 v6, 2752, v8
    v_lshl_add_u32 v6, v9, 4, v6
    s_mov_b32 s50, -1
    s_mov_b32 s51, 0x0fffffff
    s_mov_b32 s52, -1
    s_mov_b32 s53, 0x0000ffff
    s_lshl_b32 s48, s33, 10
    s_add_u32 s48, s48, 2097152
    s_mul_i32 s35, s31, 192
    s_mov_b32 s54, 0
    s_mov_b32 s55, 0
k3_lloop:
    s_add_u32 m0, s54, 0
    s_add_u32 s36, s48, 0
    buffer_load_dwordx4 v4, s[16:19], s36 offen lds
    s_add_u32 m0, s54, 1024
    s_add_u32 s36, s48, 8192
    buffer_load_dwordx4 v5, s[16:19], s36 offen lds
    s_add_u32 m0, s54, 2048
    s_add_u32 s36, s48, 16384
    buffer_load_dwordx4 v4, s[16:19], s36 offen lds
    s_add_u32 m0, s54, 3072
    s_add_u32 s36, s48, 24576
    buffer_load_dwordx4 v5, s[16:19], s36 offen lds
    s_add_u32 m0, s54, 4096
    s_add_u32 s36, s48, 32768
    buffer_load_dwordx4 v4, s[16:19], s36 offen lds
    s_add_u32 m0, s54, 5120
    s_add_u32 s36, s48, 40960
    buffer_load_dwordx4 v5, s[16:19], s36 offen lds
    s_add_u32 m0, s54, 6144
    s_add_u32 s36, s48, 49152
    buffer_load_dwordx4 v4, s[16:19], s36 offen lds
    s_add_u32 m0, s54, 7168
    s_add_u32 s36, s48, 57344
    buffer_load_dwordx4 v5, s[16:19], s36 offen lds
    s_add_u32 m0, s54, 8192
    s_add_u32 s36, s48, 65536
    buffer_load_dwordx4 v4, s[16:19], s36 offen lds
    s_add_u32 m0, s54, 9216
    s_add_u32 s36, s48, 73728
    buffer_load_dwordx4 v5, s[16:19], s36 offen lds
    s_add_u32 m0, s54, 10240
    s_add_u32 s36, s48, 81920
    buffer_load_dwordx4 v4, s[16:19], s36 offen lds
    s_add_u32 m0, s54, 11264
    s_add_u32 s36, s48, 90112
    buffer_load_dwordx4 v5, s[16:19], s36 offen lds
    s_add_u32 m0, s54, 12288
    s_add_u32 s36, s48, 98304
    buffer_load_dwordx4 v4, s[16:19], s36 offen lds
    s_add_u32 m0, s54, 13312
    s_add_u32 s36, s48, 106496
    buffer_load_dwordx4 v5, s[16:19], s36 offen lds
    s_add_u32 m0, s54, 14336
    s_add_u32 s36, s48, 114688
    buffer_load_dwordx4 v4, s[16:19], s36 offen lds
    s_add_u32 m0, s54, 15360
    s_add_u32 s36, s48, 122880
    buffer_load_dwordx4 v5, s[16:19], s36 offen lds
    s_mov_b64 exec, s[50:51]
    s_add_u32 m0, s54, 16384
    s_add_u32 s36, s35, 0
    buffer_load_dwordx4 v6, s[8:11], s36 offen lds
    s_add_u32 m0, s54, 17344
    s_add_u32 s36, s35, 13760
    buffer_load_dwordx4 v6, s[8:11], s36 offen lds
    s_add_u32 m0, s54, 18304
    s_add_u32 s36, s35, 27520
    buffer_load_dwordx4 v6, s[8:11], s36 offen lds
    s_add_u32 m0, s54, 19264
    s_add_u32 s36, s35, 41280
    buffer_load_dwordx4 v6, s[8:11], s36 offen lds
    s_add_u32 m0, s54, 20224
    s_add_u32 s36, s35, 55040
    buffer_load_dwordx4 v6, s[8:11], s36 offen lds
    s_add_u32 m0, s54, 21184
    s_add_u32 s36, s35, 68800
    buffer_load_dwordx4 v6, s[8:11], s36 offen lds
    s_add_u32 m0, s54, 22144
    s_add_u32 s36, s35, 82560
    buffer_load_dwordx4 v6, s[8:11], s36 offen lds
    s_add_u32 m0, s54, 23104
    s_add_u32 s36, s35, 96320
    buffer_load_dwordx4 v6, s[8:11], s36 offen lds
    s_add_u32 m0, s54, 24064
    s_add_u32 s36, s35, 110080
    buffer_load_dwordx4 v6, s[8:11], s36 offen lds
    s_add_u32 m0, s54, 25024
    s_add_u32 s36, s35, 123840
    buffer_load_dwordx4 v6, s[8:11], s36 offen lds
    s_add_u32 m0, s54, 25984
    s_add_u32 s36, s35, 137600
    buffer_load_dwordx4 v6, s[8:11], s36 offen lds
    s_add_u32 m0, s54, 26944
    s_add_u32 s36, s35, 151360
    buffer_load_dwordx4 v6, s[8:11], s36 offen lds
    s_mov_b64 exec, s[52:53]
    s_add_u32 m0, s54, 27904
    s_add_u32 s36, s35, 165120
    buffer_load_dwordx4 v6, s[8:11], s36 offen lds
    s_mov_b64 exec, -1
    s_mov_b64 exec, s[50:51]
    s_add_u32 m0, s54, 28672
    s_add_u32 s36, s35, 0
    buffer_load_dwordx4 v6, s[12:15], s36 offen lds
    s_add_u32 m0, s54, 29632
    s_add_u32 s36, s35, 13760
    buffer_load_dwordx4 v6, s[12:15], s36 offen lds
    s_add_u32 m0, s54, 30592
    s_add_u32 s36, s35, 27520
    buffer_load_dwordx4 v6, s[12:15], s36 offen lds
    s_add_u32 m0, s54, 31552
    s_add_u32 s36, s35, 41280
    buffer_load_dwordx4 v6, s[12:15], s36 offen lds
    s_add_u32 m0, s54, 32512
    s_add_u32 s36, s35, 55040
    buffer_load_dwordx4 v6, s[12:15], s36 offen lds
    s_add_u32 m0, s54, 33472
    s_add_u32 s36, s35, 68800
    buffer_load_dwordx4 v6, s[12:15], s36 offen lds
    s_add_u32 m0, s54, 34432
    s_add_u32 s36, s35, 82560
    buffer_load_dwordx4 v6, s[12:15], s36 offen lds
    s_add_u32 m0, s54, 35392
    s_add_u32 s36, s35, 96320
    buffer_load_dwordx4 v6, s[12:15], s36 offen lds
    s_add_u32 m0, s54, 36352
    s_add_u32 s36, s35, 110080
    buffer_load_dwordx4 v6, s[12:15], s36 offen lds
    s_add_u32 m0, s54, 37312
    s_add_u32 s36, s35, 123840
    buffer_load_dwordx4 v6, s[12:15], s36 offen lds
    s_add_u32 m0, s54, 38272
    s_add_u32 s36, s35, 137600
    buffer_load_dwordx4 v6, s[12:15], s36 offen lds
    s_add_u32 m0, s54, 39232
    s_add_u32 s36, s35, 151360
    buffer_load_dwordx4 v6, s[12:15], s36 offen lds
    s_mov_b64 exec, s[52:53]
    s_add_u32 m0, s54, 40192
    s_add_u32 s36, s35, 165120
    buffer_load_dwordx4 v6, s[12:15], s36 offen lds
    s_mov_b64 exec, -1
    s_add_u32 s48, s48, 128
    s_add_u32 s35, s35, 176128
    s_add_u32 s54, s54, 40960
    s_cmp_eq_u32 s54, 163840
    s_cselect_b32 s54, 0, s54
    s_add_u32 s55, s55, 1
    s_cmp_eq_u32 s55, 1
    s_cbranch_scc1 k3_lloop
    s_waitcnt vmcnt(42)
    s_barrier
    s_cmp_lt_u32 s55, 8
    s_cbranch_scc1 k3_lloop
    s_waitcnt vmcnt(0)
    s_barrier
    s_endpgm
k3_compute:
    v_add_u32 v8, s47, v2
    v_lshlrev_b32 v8, 7, v8
    s_mov_b32 s39, 13631488
    buffer_load_dwordx4 v[128:131], v8, s[16:19], s39 offen offset:0
    buffer_load_dwordx4 v[132:135], v8, s[16:19], s39 offen offset:16
    buffer_load_dwordx4 v[136:139], v8, s[16:19], s39 offen offset:32
    buffer_load_dwordx4 v[140:143], v8, s[16:19], s39 offen offset:48
    buffer_load_dwordx4 v[144:147], v8, s[16:19], s39 offen offset:64
    buffer_load_dwordx4 v[148:151], v8, s[16:19], s39 offen offset:80
    buffer_load_dwordx4 v[152:155], v8, s[16:19], s39 offen offset:96
    buffer_load_dwordx4 v[156:159], v8, s[16:19], s39 offen offset:112
    v_lshrrev_b32 v8, 5, v1
    v_lshlrev_b32 v8, 3, v8
    v_bfe_u32 v9, v1, 2, 2
    v_add_u32 v8, v8, v9
    v_mul_u32_u24 v7, 192, v8
    v_bfe_u32 v9, v1, 4, 1
    v_lshl_add_u32 v7, v9, 5, v7
    v_and_b32 v9, 3, v1
    v_lshl_add_u32 v7, v9, 3, v7
    v_add_u32 v8, s34, v2
    v_bfe_u32 v9, v8, 1, 3
    v_xor_b32 v9, v9, v3
    v_lshlrev_b32 v8, 7, v8
    v_xor_b32 v10, 0, v9
    v_lshl_add_u32 v96, v10, 4, v8
    v_xor_b32 v10, 2, v9
    v_lshl_add_u32 v97, v10, 4, v8
    v_xor_b32 v10, 4, v9
    v_lshl_add_u32 v98, v10, 4, v8
    v_xor_b32 v10, 6, v9
    v_lshl_add_u32 v99, v10, 4, v8
    v_mov_b32 v108, v7
    v_mov_b32 v112, v96
    v_mov_b32 v113, v97
    v_mov_b32 v114, v98
    v_mov_b32 v115, v99
    s_mov_b32 s56, 40960
    s_mov_b32 s57, 0
    v_mov_b32 v94, 0x3f803f80
    v_mov_b32 v64, 0
    v_mov_b32 v65, 0
    v_mov_b32 v66, 0
    v_mov_b32 v67, 0
    v_mov_b32 v68, 0
    v_mov_b32 v69, 0
    v_mov_b32 v70, 0
    v_mov_b32 v71, 0
    v_mov_b32 v72, 0
    v_mov_b32 v73, 0
    v_mov_b32 v74, 0
    v_mov_b32 v75, 0
    v_mov_b32 v76, 0
    v_mov_b32 v77, 0
    v_mov_b32 v78, 0
    v_mov_b32 v79, 0
    v_mov_b32 v80, 0
    v_mov_b32 v81, 0
    v_mov_b32 v82, 0
    v_mov_b32 v83, 0
    v_mov_b32 v84, 0
    v_mov_b32 v85, 0
    v_mov_b32 v86, 0
    v_mov_b32 v87, 0
    v_mov_b32 v160, 0
    v_mov_b32 v161, 0
    v_mov_b32 v162, 0
    v_mov_b32 v163, 0
    v_mov_b32 v164, 0
    v_mov_b32 v165, 0
    v_mov_b32 v166, 0
    v_mov_b32 v167, 0
    v_mov_b32 v168, 0
    v_mov_b32 v169, 0
    v_mov_b32 v170, 0
    v_mov_b32 v171, 0
    v_mov_b32 v172, 0
    v_mov_b32 v173, 0
    v_mov_b32 v174, 0
    v_mov_b32 v175, 0
    v_mov_b32 v176, 0
    v_mov_b32 v177, 0
    v_mov_b32 v178, 0
    v_mov_b32 v179, 0
    v_mov_b32 v180, 0
    v_mov_b32 v181, 0
    v_mov_b32 v182, 0
    v_mov_b32 v183, 0
    v_mov_b32 v184, 0
    v_mov_b32 v185, 0
    v_mov_b32 v186, 0
    v_mov_b32 v187, 0
    v_mov_b32 v188, 0
    v_mov_b32 v189, 0
    v_mov_b32 v190, 0
    v_mov_b32 v191, 0
    v_mov_b32 v192, 0
    v_mov_b32 v193, 0
    v_mov_b32 v194, 0
    v_mov_b32 v195, 0
    v_mov_b32 v196, 0
    v_mov_b32 v197, 0
    v_mov_b32 v198, 0
    v_mov_b32 v199, 0
    v_mov_b32 v200, 0
    v_mov_b32 v201, 0
    v_mov_b32 v202, 0
    v_mov_b32 v203, 0
    v_mov_b32 v204, 0
    v_mov_b32 v205, 0
    v_mov_b32 v206, 0
    v_mov_b32 v207, 0
    v_mov_b32 v208, 0
    v_mov_b32 v209, 0
    v_mov_b32 v210, 0
    v_mov_b32 v211, 0
    v_mov_b32 v212, 0
    v_mov_b32 v213, 0
    v_mov_b32 v214, 0
    v_mov_b32 v215, 0
    v_mov_b32 v216, 0
    v_mov_b32 v217, 0
    v_mov_b32 v218, 0
    v_mov_b32 v219, 0
    v_mov_b32 v220, 0
    v_mov_b32 v221, 0
    v_mov_b32 v222, 0
    v_mov_b32 v223, 0
    v_mov_b32 v224, 0
    v_mov_b32 v225, 0
    v_mov_b32 v226, 0
    v_mov_b32 v227, 0
    v_mov_b32 v228, 0
    v_mov_b32 v229, 0
    v_mov_b32 v230, 0
    v_mov_b32 v231, 0
    v_mov_b32 v232, 0
    v_mov_b32 v233, 0
    v_mov_b32 v234, 0
    v_mov_b32 v235, 0
    v_mov_b32 v236, 0
    v_mov_b32 v237, 0
    v_mov_b32 v238, 0
    v_mov_b32 v239, 0
    v_mov_b32 v240, 0
    v_mov_b32 v241, 0
    v_mov_b32 v242, 0
    v_mov_b32 v243, 0
    v_mov_b32 v244, 0
    v_mov_b32 v245, 0
    v_mov_b32 v246, 0
    v_mov_b32 v247, 0
    v_mov_b32 v248, 0
    v_mov_b32 v249, 0
    v_mov_b32 v250, 0
    v_mov_b32 v251, 0
    v_mov_b32 v252, 0
    v_mov_b32 v253, 0
    v_mov_b32 v254, 0
    v_mov_b32 v255, 0
    s_barrier
    ds_read_b128 v[100:103], v112
    ds_read_b64_tr_b16 v[16:17], v108 offset:16384
    ds_read_b64_tr_b16 v[18:19], v108 offset:17152
    ds_read_b64_tr_b16 v[20:21], v108 offset:16448
    ds_read_b64_tr_b16 v[22:23], v108 offset:17216
    ds_read_b64_tr_b16 v[24:25], v108 offset:16512
    ds_read_b64_tr_b16 v[26:27], v108 offset:17280
    ds_read_b64_tr_b16 v[28:29], v108 offset:28672
    ds_read_b64_tr_b16 v[30:31], v108 offset:29440
    ds_read_b64_tr_b16 v[32:33], v108 offset:28736
    ds_read_b64_tr_b16 v[34:35], v108 offset:29504
    ds_read_b64_tr_b16 v[36:37], v108 offset:28800
    ds_read_b64_tr_b16 v[38:39], v108 offset:29568
k3_cloop:
    v_add_u32 v109, s56, v7
    v_add_u32 v116, s56, v96
    s_waitcnt lgkmcnt(0)
    v_mfma_f32_32x32x16_bf16 v[160:175], v[16:19], v[100:103], v[160:175]
    ds_read_b128 v[104:107], v113
    ds_read_b64_tr_b16 v[40:41], v108 offset:19456
    ds_read_b64_tr_b16 v[42:43], v108 offset:20224
    v_mfma_f32_32x32x16_bf16 v[176:191], v[20:23], v[100:103], v[176:191]
    ds_read_b64_tr_b16 v[44:45], v108 offset:19520
    ds_read_b64_tr_b16 v[46:47], v108 offset:20288
    v_mfma_f32_32x32x16_bf16 v[192:207], v[24:27], v[100:103], v[192:207]
    ds_read_b64_tr_b16 v[48:49], v108 offset:19584
    ds_read_b64_tr_b16 v[50:51], v108 offset:20352
    v_mfma_f32_32x32x16_bf16 v[208:223], v[28:31], v[100:103], v[208:223]
    ds_read_b64_tr_b16 v[52:53], v108 offset:31744
    ds_read_b64_tr_b16 v[54:55], v108 offset:32512
    v_mfma_f32_32x32x16_bf16 v[224:239], v[32:35], v[100:103], v[224:239]
    ds_read_b64_tr_b16 v[56:57], v108 offset:31808
    ds_read_b64_tr_b16 v[58:59], v108 offset:32576
    v_mfma_f32_32x32x16_bf16 v[240:255], v[36:39], v[100:103], v[240:255]
    ds_read_b64_tr_b16 v[60:61], v108 offset:31872
    ds_read_b64_tr_b16 v[62:63], v108 offset:32640
    s_cmp_lg_u32 s32, 0
    s_cbranch_scc1 k3_csa0
    v_dot2_f32_bf16 v64, v16, v94, v64
    v_dot2_f32_bf16 v65, v17, v94, v65
    v_dot2_f32_bf16 v66, v18, v94, v66
    v_dot2_f32_bf16 v67, v19, v94, v67
    v_dot2_f32_bf16 v68, v20, v94, v68
    v_dot2_f32_bf16 v69, v21, v94, v69
    v_dot2_f32_bf16 v70, v22, v94, v70
    v_dot2_f32_bf16 v71, v23, v94, v71
    v_dot2_f32_bf16 v72, v24, v94, v72
    v_dot2_f32_bf16 v73, v25, v94, v73
    v_dot2_f32_bf16 v74, v26, v94, v74
    v_dot2_f32_bf16 v75, v27, v94, v75
    v_dot2_f32_bf16 v76, v28, v94, v76
    v_dot2_f32_bf16 v77, v29, v94, v77
    v_dot2_f32_bf16 v78, v30, v94, v78
    v_dot2_f32_bf16 v79, v31, v94, v79
    v_dot2_f32_bf16 v80, v32, v94, v80
    v_dot2_f32_bf16 v81, v33, v94, v81
    v_dot2_f32_bf16 v82, v34, v94, v82
    v_dot2_f32_bf16 v83, v35, v94, v83
    v_dot2_f32_bf16 v84, v36, v94, v84
    v_dot2_f32_bf16 v85, v37, v94, v85
    v_dot2_f32_bf16 v86, v38, v94, v86
    v_dot2_f32_bf16 v87, v39, v94, v87
k3_csa0:
    s_waitcnt lgkmcnt(0)
    v_mfma_f32_32x32x16_bf16 v[160:175], v[40:43], v[104:107], v[160:175]
    ds_read_b128 v[100:103], v114
    ds_read_b64_tr_b16 v[16:17], v108 offset:22528
    ds_read_b64_tr_b16 v[18:19], v108 offset:23296
    v_mfma_f32_32x32x16_bf16 v[176:191], v[44:47], v[104:107], v[176:191]
    ds_read_b64_tr_b16 v[20:21], v108 offset:22592
    ds_read_b64_tr_b16 v[22:23], v108 offset:23360
    v_mfma_f32_32x32x16_bf16 v[192:207], v[48:51], v[104:107], v[192:207]
    ds_read_b64_tr_b16 v[24:25], v108 offset:22656
    ds_read_b64_tr_b16 v[26:27], v108 offset:23424
    v_mfma_f32_32x32x16_bf16 v[208:223], v[52:55], v[104:107], v[208:223]
    ds_read_b64_tr_b16 v[28:29], v108 offset:34816
    ds_read_b64_tr_b16 v[30:31], v108 offset:35584
    v_mfma_f32_32x32x16_bf16 v[224:239], v[56:59], v[104:107], v[224:239]
    ds_read_b64_tr_b16 v[32:33], v108 offset:34880
    ds_read_b64_tr_b16 v[34:35], v108 offset:35648
    v_mfma_f32_32x32x16_bf16 v[240:255], v[60:63], v[104:107], v[240:255]
    ds_read_b64_tr_b16 v[36:37], v108 offset:34944
    ds_read_b64_tr_b16 v[38:39], v108 offset:35712
    s_cmp_lg_u32 s32, 1
    s_cbranch_scc1 k3_csa1
    v_dot2_f32_bf16 v64, v40, v94, v64
    v_dot2_f32_bf16 v65, v41, v94, v65
    v_dot2_f32_bf16 v66, v42, v94, v66
    v_dot2_f32_bf16 v67, v43, v94, v67
    v_dot2_f32_bf16 v68, v44, v94, v68
    v_dot2_f32_bf16 v69, v45, v94, v69
    v_dot2_f32_bf16 v70, v46, v94, v70
    v_dot2_f32_bf16 v71, v47, v94, v71
    v_dot2_f32_bf16 v72, v48, v94, v72
    v_dot2_f32_bf16 v73, v49, v94, v73
    v_dot2_f32_bf16 v74, v50, v94, v74
    v_dot2_f32_bf16 v75, v51, v94, v75
    v_dot2_f32_bf16 v76, v52, v94, v76
    v_dot2_f32_bf16 v77, v53, v94, v77
    v_dot2_f32_bf16 v78, v54, v94, v78
    v_dot2_f32_bf16 v79, v55, v94, v79
    v_dot2_f32_bf16 v80, v56, v94, v80
    v_dot2_f32_bf16 v81, v57, v94, v81
    v_dot2_f32_bf16 v82, v58, v94, v82
    v_dot2_f32_bf16 v83, v59, v94, v83
    v_dot2_f32_bf16 v84, v60, v94, v84
    v_dot2_f32_bf16 v85, v61, v94, v85
    v_dot2_f32_bf16 v86, v62, v94, v86
    v_dot2_f32_bf16 v87, v63, v94, v87
k3_csa1:
    s_waitcnt lgkmcnt(0)
    v_mfma_f32_32x32x16_bf16 v[160:175], v[16:19], v[100:103], v[160:175]
    ds_read_b128 v[104:107], v115
    ds_read_b64_tr_b16 v[40:41], v108 offset:25600
    ds_read_b64_tr_b16 v[42:43], v108 offset:26368
    v_mfma_f32_32x32x16_bf16 v[176:191], v[20:23], v[100:103], v[176:191]
    ds_read_b64_tr_b16 v[44:45], v108 offset:25664
    ds_read_b64_tr_b16 v[46:47], v108 offset:26432
    v_mfma_f32_32x32x16_bf16 v[192:207], v[24:27], v[100:103], v[192:207]
    ds_read_b64_tr_b16 v[48:49], v108 offset:25728
    ds_read_b64_tr_b16 v[50:51], v108 offset:26496
    v_mfma_f32_32x32x16_bf16 v[208:223], v[28:31], v[100:103], v[208:223]
    ds_read_b64_tr_b16 v[52:53], v108 offset:37888
    ds_read_b64_tr_b16 v[54:55], v108 offset:38656
    v_mfma_f32_32x32x16_bf16 v[224:239], v[32:35], v[100:103], v[224:239]
    ds_read_b64_tr_b16 v[56:57], v108 offset:37952
    ds_read_b64_tr_b16 v[58:59], v108 offset:38720
    v_mfma_f32_32x32x16_bf16 v[240:255], v[36:39], v[100:103], v[240:255]
    ds_read_b64_tr_b16 v[60:61], v108 offset:38016
    ds_read_b64_tr_b16 v[62:63], v108 offset:38784
    s_cmp_lg_u32 s32, 2
    s_cbranch_scc1 k3_csa2
    v_dot2_f32_bf16 v64, v16, v94, v64
    v_dot2_f32_bf16 v65, v17, v94, v65
    v_dot2_f32_bf16 v66, v18, v94, v66
    v_dot2_f32_bf16 v67, v19, v94, v67
    v_dot2_f32_bf16 v68, v20, v94, v68
    v_dot2_f32_bf16 v69, v21, v94, v69
    v_dot2_f32_bf16 v70, v22, v94, v70
    v_dot2_f32_bf16 v71, v23, v94, v71
    v_dot2_f32_bf16 v72, v24, v94, v72
    v_dot2_f32_bf16 v73, v25, v94, v73
    v_dot2_f32_bf16 v74, v26, v94, v74
    v_dot2_f32_bf16 v75, v27, v94, v75
    v_dot2_f32_bf16 v76, v28, v94, v76
    v_dot2_f32_bf16 v77, v29, v94, v77
    v_dot2_f32_bf16 v78, v30, v94, v78
    v_dot2_f32_bf16 v79, v31, v94, v79
    v_dot2_f32_bf16 v80, v32, v94, v80
    v_dot2_f32_bf16 v81, v33, v94, v81
    v_dot2_f32_bf16 v82, v34, v94, v82
    v_dot2_f32_bf16 v83, v35, v94, v83
    v_dot2_f32_bf16 v84, v36, v94, v84
    v_dot2_f32_bf16 v85, v37, v94, v85
    v_dot2_f32_bf16 v86, v38, v94, v86
    v_dot2_f32_bf16 v87, v39, v94, v87
k3_csa2:
    s_waitcnt lgkmcnt(0)
    s_barrier
    v_mfma_f32_32x32x16_bf16 v[160:175], v[40:43], v[104:107], v[160:175]
    ds_read_b128 v[100:103], v116
    ds_read_b64_tr_b16 v[16:17], v109 offset:16384
    ds_read_b64_tr_b16 v[18:19], v109 offset:17152
    v_mfma_f32_32x32x16_bf16 v[176:191], v[44:47], v[104:107], v[176:191]
    ds_read_b64_tr_b16 v[20:21], v109 offset:16448
    ds_read_b64_tr_b16 v[22:23], v109 offset:17216
    v_mfma_f32_32x32x16_bf16 v[192:207], v[48:51], v[104:107], v[192:207]
    ds_read_b64_tr_b16 v[24:25], v109 offset:16512
    ds_read_b64_tr_b16 v[26:27], v109 offset:17280
    v_mfma_f32_32x32x16_bf16 v[208:223], v[52:55], v[104:107], v[208:223]
    ds_read_b64_tr_b16 v[28:29], v109 offset:28672
    ds_read_b64_tr_b16 v[30:31], v109 offset:29440
    v_mfma_f32_32x32x16_bf16 v[224:239], v[56:59], v[104:107], v[224:239]
    ds_read_b64_tr_b16 v[32:33], v109 offset:28736
    ds_read_b64_tr_b16 v[34:35], v109 offset:29504
    v_mfma_f32_32x32x16_bf16 v[240:255], v[60:63], v[104:107], v[240:255]
    ds_read_b64_tr_b16 v[36:37], v109 offset:28800
    ds_read_b64_tr_b16 v[38:39], v109 offset:29568
    s_cmp_lg_u32 s32, 3
    s_cbranch_scc1 k3_csa3
    v_dot2_f32_bf16 v64, v40, v94, v64
    v_dot2_f32_bf16 v65, v41, v94, v65
    v_dot2_f32_bf16 v66, v42, v94, v66
    v_dot2_f32_bf16 v67, v43, v94, v67
    v_dot2_f32_bf16 v68, v44, v94, v68
    v_dot2_f32_bf16 v69, v45, v94, v69
    v_dot2_f32_bf16 v70, v46, v94, v70
    v_dot2_f32_bf16 v71, v47, v94, v71
    v_dot2_f32_bf16 v72, v48, v94, v72
    v_dot2_f32_bf16 v73, v49, v94, v73
    v_dot2_f32_bf16 v74, v50, v94, v74
    v_dot2_f32_bf16 v75, v51, v94, v75
    v_dot2_f32_bf16 v76, v52, v94, v76
    v_dot2_f32_bf16 v77, v53, v94, v77
    v_dot2_f32_bf16 v78, v54, v94, v78
    v_dot2_f32_bf16 v79, v55, v94, v79
    v_dot2_f32_bf16 v80, v56, v94, v80
    v_dot2_f32_bf16 v81, v57, v94, v81
    v_dot2_f32_bf16 v82, v58, v94, v82
    v_dot2_f32_bf16 v83, v59, v94, v83
    v_dot2_f32_bf16 v84, v60, v94, v84
    v_dot2_f32_bf16 v85, v61, v94, v85
    v_dot2_f32_bf16 v86, v62, v94, v86
    v_dot2_f32_bf16 v87, v63, v94, v87
k3_csa3:
    v_mov_b32 v108, v109
    v_add_u32 v112, s56, v96
    v_add_u32 v113, s56, v97
    v_add_u32 v114, s56, v98
    v_add_u32 v115, s56, v99
    s_add_u32 s56, s56, 40960
    s_cmp_eq_u32 s56, 163840
    s_cselect_b32 s56, 0, s56
    s_add_u32 s57, s57, 1
    s_cmp_lt_u32 s57, 7
    s_cbranch_scc1 k3_cloop
    s_waitcnt lgkmcnt(0)
    v_mfma_f32_32x32x16_bf16 v[160:175], v[16:19], v[100:103], v[160:175]
    ds_read_b128 v[104:107], v113
    ds_read_b64_tr_b16 v[40:41], v108 offset:19456
    ds_read_b64_tr_b16 v[42:43], v108 offset:20224
    v_mfma_f32_32x32x16_bf16 v[176:191], v[20:23], v[100:103], v[176:191]
    ds_read_b64_tr_b16 v[44:45], v108 offset:19520
    ds_read_b64_tr_b16 v[46:47], v108 offset:20288
    v_mfma_f32_32x32x16_bf16 v[192:207], v[24:27], v[100:103], v[192:207]
    ds_read_b64_tr_b16 v[48:49], v108 offset:19584
    ds_read_b64_tr_b16 v[50:51], v108 offset:20352
    v_mfma_f32_32x32x16_bf16 v[208:223], v[28:31], v[100:103], v[208:223]
    ds_read_b64_tr_b16 v[52:53], v108 offset:31744
    ds_read_b64_tr_b16 v[54:55], v108 offset:32512
    v_mfma_f32_32x32x16_bf16 v[224:239], v[32:35], v[100:103], v[224:239]
    ds_read_b64_tr_b16 v[56:57], v108 offset:31808
    ds_read_b64_tr_b16 v[58:59], v108 offset:32576
    v_mfma_f32_32x32x16_bf16 v[240:255], v[36:39], v[100:103], v[240:255]
    ds_read_b64_tr_b16 v[60:61], v108 offset:31872
    ds_read_b64_tr_b16 v[62:63], v108 offset:32640
    s_cmp_lg_u32 s32, 0
    s_cbranch_scc1 k3_csb0
    v_dot2_f32_bf16 v64, v16, v94, v64
    v_dot2_f32_bf16 v65, v17, v94, v65
    v_dot2_f32_bf16 v66, v18, v94, v66
    v_dot2_f32_bf16 v67, v19, v94, v67
    v_dot2_f32_bf16 v68, v20, v94, v68
    v_dot2_f32_bf16 v69, v21, v94, v69
    v_dot2_f32_bf16 v70, v22, v94, v70
    v_dot2_f32_bf16 v71, v23, v94, v71
    v_dot2_f32_bf16 v72, v24, v94, v72
    v_dot2_f32_bf16 v73, v25, v94, v73
    v_dot2_f32_bf16 v74, v26, v94, v74
    v_dot2_f32_bf16 v75, v27, v94, v75
    v_dot2_f32_bf16 v76, v28, v94, v76
    v_dot2_f32_bf16 v77, v29, v94, v77
    v_dot2_f32_bf16 v78, v30, v94, v78
    v_dot2_f32_bf16 v79, v31, v94, v79
    v_dot2_f32_bf16 v80, v32, v94, v80
    v_dot2_f32_bf16 v81, v33, v94, v81
    v_dot2_f32_bf16 v82, v34, v94, v82
    v_dot2_f32_bf16 v83, v35, v94, v83
    v_dot2_f32_bf16 v84, v36, v94, v84
    v_dot2_f32_bf16 v85, v37, v94, v85
    v_dot2_f32_bf16 v86, v38, v94, v86
    v_dot2_f32_bf16 v87, v39, v94, v87
k3_csb0:
    s_waitcnt lgkmcnt(0)
    v_mfma_f32_32x32x16_bf16 v[160:175], v[40:43], v[104:107], v[160:175]
    ds_read_b128 v[100:103], v114
    ds_read_b64_tr_b16 v[16:17], v108 offset:22528
    ds_read_b64_tr_b16 v[18:19], v108 offset:23296
    v_mfma_f32_32x32x16_bf16 v[176:191], v[44:47], v[104:107], v[176:191]
    ds_read_b64_tr_b16 v[20:21], v108 offset:22592
    ds_read_b64_tr_b16 v[22:23], v108 offset:23360
    v_mfma_f32_32x32x16_bf16 v[192:207], v[48:51], v[104:107], v[192:207]
    ds_read_b64_tr_b16 v[24:25], v108 offset:22656
    ds_read_b64_tr_b16 v[26:27], v108 offset:23424
    v_mfma_f32_32x32x16_bf16 v[208:223], v[52:55], v[104:107], v[208:223]
    ds_read_b64_tr_b16 v[28:29], v108 offset:34816
    ds_read_b64_tr_b16 v[30:31], v108 offset:35584
    v_mfma_f32_32x32x16_bf16 v[224:239], v[56:59], v[104:107], v[224:239]
    ds_read_b64_tr_b16 v[32:33], v108 offset:34880
    ds_read_b64_tr_b16 v[34:35], v108 offset:35648
    v_mfma_f32_32x32x16_bf16 v[240:255], v[60:63], v[104:107], v[240:255]
    ds_read_b64_tr_b16 v[36:37], v108 offset:34944
    ds_read_b64_tr_b16 v[38:39], v108 offset:35712
    s_cmp_lg_u32 s32, 1
    s_cbranch_scc1 k3_csb1
    v_dot2_f32_bf16 v64, v40, v94, v64
    v_dot2_f32_bf16 v65, v41, v94, v65
    v_dot2_f32_bf16 v66, v42, v94, v66
    v_dot2_f32_bf16 v67, v43, v94, v67
    v_dot2_f32_bf16 v68, v44, v94, v68
    v_dot2_f32_bf16 v69, v45, v94, v69
    v_dot2_f32_bf16 v70, v46, v94, v70
    v_dot2_f32_bf16 v71, v47, v94, v71
    v_dot2_f32_bf16 v72, v48, v94, v72
    v_dot2_f32_bf16 v73, v49, v94, v73
    v_dot2_f32_bf16 v74, v50, v94, v74
    v_dot2_f32_bf16 v75, v51, v94, v75
    v_dot2_f32_bf16 v76, v52, v94, v76
    v_dot2_f32_bf16 v77, v53, v94, v77
    v_dot2_f32_bf16 v78, v54, v94, v78
    v_dot2_f32_bf16 v79, v55, v94, v79
    v_dot2_f32_bf16 v80, v56, v94, v80
    v_dot2_f32_bf16 v81, v57, v94, v81
    v_dot2_f32_bf16 v82, v58, v94, v82
    v_dot2_f32_bf16 v83, v59, v94, v83
    v_dot2_f32_bf16 v84, v60, v94, v84
    v_dot2_f32_bf16 v85, v61, v94, v85
    v_dot2_f32_bf16 v86, v62, v94, v86
    v_dot2_f32_bf16 v87, v63, v94, v87
k3_csb1:
    s_waitcnt lgkmcnt(0)
    v_mfma_f32_32x32x16_bf16 v[160:175], v[16:19], v[100:103], v[160:175]
    ds_read_b128 v[104:107], v115
    ds_read_b64_tr_b16 v[40:41], v108 offset:25600
    ds_read_b64_tr_b16 v[42:43], v108 offset:26368
    v_mfma_f32_32x32x16_bf16 v[176:191], v[20:23], v[100:103], v[176:191]
    ds_read_b64_tr_b16 v[44:45], v108 offset:25664
    ds_read_b64_tr_b16 v[46:47], v108 offset:26432
    v_mfma_f32_32x32x16_bf16 v[192:207], v[24:27], v[100:103], v[192:207]
    ds_read_b64_tr_b16 v[48:49], v108 offset:25728
    ds_read_b64_tr_b16 v[50:51], v108 offset:26496
    v_mfma_f32_32x32x16_bf16 v[208:223], v[28:31], v[100:103], v[208:223]
    ds_read_b64_tr_b16 v[52:53], v108 offset:37888
    ds_read_b64_tr_b16 v[54:55], v108 offset:38656
    v_mfma_f32_32x32x16_bf16 v[224:239], v[32:35], v[100:103], v[224:239]
    ds_read_b64_tr_b16 v[56:57], v108 offset:37952
    ds_read_b64_tr_b16 v[58:59], v108 offset:38720
    v_mfma_f32_32x32x16_bf16 v[240:255], v[36:39], v[100:103], v[240:255]
    ds_read_b64_tr_b16 v[60:61], v108 offset:38016
    ds_read_b64_tr_b16 v[62:63], v108 offset:38784
    s_cmp_lg_u32 s32, 2
    s_cbranch_scc1 k3_csb2
    v_dot2_f32_bf16 v64, v16, v94, v64
    v_dot2_f32_bf16 v65, v17, v94, v65
    v_dot2_f32_bf16 v66, v18, v94, v66
    v_dot2_f32_bf16 v67, v19, v94, v67
    v_dot2_f32_bf16 v68, v20, v94, v68
    v_dot2_f32_bf16 v69, v21, v94, v69
    v_dot2_f32_bf16 v70, v22, v94, v70
    v_dot2_f32_bf16 v71, v23, v94, v71
    v_dot2_f32_bf16 v72, v24, v94, v72
    v_dot2_f32_bf16 v73, v25, v94, v73
    v_dot2_f32_bf16 v74, v26, v94, v74
    v_dot2_f32_bf16 v75, v27, v94, v75
    v_dot2_f32_bf16 v76, v28, v94, v76
    v_dot2_f32_bf16 v77, v29, v94, v77
    v_dot2_f32_bf16 v78, v30, v94, v78
    v_dot2_f32_bf16 v79, v31, v94, v79
    v_dot2_f32_bf16 v80, v32, v94, v80
    v_dot2_f32_bf16 v81, v33, v94, v81
    v_dot2_f32_bf16 v82, v34, v94, v82
    v_dot2_f32_bf16 v83, v35, v94, v83
    v_dot2_f32_bf16 v84, v36, v94, v84
    v_dot2_f32_bf16 v85, v37, v94, v85
    v_dot2_f32_bf16 v86, v38, v94, v86
    v_dot2_f32_bf16 v87, v39, v94, v87
k3_csb2:
    s_waitcnt lgkmcnt(0)
    v_mfma_f32_32x32x16_bf16 v[160:175], v[40:43], v[104:107], v[160:175]
    v_mfma_f32_32x32x16_bf16 v[176:191], v[44:47], v[104:107], v[176:191]
    v_mfma_f32_32x32x16_bf16 v[192:207], v[48:51], v[104:107], v[192:207]
    v_mfma_f32_32x32x16_bf16 v[208:223], v[52:55], v[104:107], v[208:223]
    v_mfma_f32_32x32x16_bf16 v[224:239], v[56:59], v[104:107], v[224:239]
    v_mfma_f32_32x32x16_bf16 v[240:255], v[60:63], v[104:107], v[240:255]
    s_cmp_lg_u32 s32, 3
    s_cbranch_scc1 k3_csb3
    v_dot2_f32_bf16 v64, v40, v94, v64
    v_dot2_f32_bf16 v65, v41, v94, v65
    v_dot2_f32_bf16 v66, v42, v94, v66
    v_dot2_f32_bf16 v67, v43, v94, v67
    v_dot2_f32_bf16 v68, v44, v94, v68
    v_dot2_f32_bf16 v69, v45, v94, v69
    v_dot2_f32_bf16 v70, v46, v94, v70
    v_dot2_f32_bf16 v71, v47, v94, v71
    v_dot2_f32_bf16 v72, v48, v94, v72
    v_dot2_f32_bf16 v73, v49, v94, v73
    v_dot2_f32_bf16 v74, v50, v94, v74
    v_dot2_f32_bf16 v75, v51, v94, v75
    v_dot2_f32_bf16 v76, v52, v94, v76
    v_dot2_f32_bf16 v77, v53, v94, v77
    v_dot2_f32_bf16 v78, v54, v94, v78
    v_dot2_f32_bf16 v79, v55, v94, v79
    v_dot2_f32_bf16 v80, v56, v94, v80
    v_dot2_f32_bf16 v81, v57, v94, v81
    v_dot2_f32_bf16 v82, v58, v94, v82
    v_dot2_f32_bf16 v83, v59, v94, v83
    v_dot2_f32_bf16 v84, v60, v94, v84
    v_dot2_f32_bf16 v85, v61, v94, v85
    v_dot2_f32_bf16 v86, v62, v94, v86
    v_dot2_f32_bf16 v87, v63, v94, v87
k3_csb3:
    s_nop 3
    v_add_f32 v64, v64, v65
    v_add_f32 v66, v66, v67
    v_add_f32 v88, v64, v66
    v_add_f32 v68, v68, v69
    v_add_f32 v70, v70, v71
    v_add_f32 v89, v68, v70
    v_add_f32 v72, v72, v73
    v_add_f32 v74, v74, v75
    v_add_f32 v90, v72, v74
    v_add_f32 v76, v76, v77
    v_add_f32 v78, v78, v79
    v_add_f32 v91, v76, v78
    v_add_f32 v80, v80, v81
    v_add_f32 v82, v82, v83
    v_add_f32 v92, v80, v82
    v_add_f32 v84, v84, v85
    v_add_f32 v86, v86, v87
    v_add_f32 v93, v84, v86
    v_mov_b32 v8, v88
    s_nop 1
    v_permlane32_swap_b32 v88, v8
    s_nop 0
    v_add_f32 v88, v88, v8
    v_mov_b32 v8, v89
    s_nop 1
    v_permlane32_swap_b32 v89, v8
    s_nop 0
    v_add_f32 v89, v89, v8
    v_mov_b32 v8, v90
    s_nop 1
    v_permlane32_swap_b32 v90, v8
    s_nop 0
    v_add_f32 v90, v90, v8
    v_mov_b32 v8, v91
    s_nop 1
    v_permlane32_swap_b32 v91, v8
    s_nop 0
    v_add_f32 v91, v91, v8
    v_mov_b32 v8, v92
    s_nop 1
    v_permlane32_swap_b32 v92, v8
    s_nop 0
    v_add_f32 v92, v92, v8
    v_mov_b32 v8, v93
    s_nop 1
    v_permlane32_swap_b32 v93, v8
    s_nop 0
    v_add_f32 v93, v93, v8
    s_mul_i32 s38, s32, 768
    s_add_u32 s38, s38, 40960
    v_lshlrev_b32 v11, 2, v2
    v_add_u32 v12, s38, v11
    ds_write_b32 v12, v88 offset:0
    ds_write_b32 v12, v89 offset:128
    ds_write_b32 v12, v90 offset:256
    ds_write_b32 v12, v91 offset:384
    ds_write_b32 v12, v92 offset:512
    ds_write_b32 v12, v93 offset:640
    s_waitcnt vmcnt(0)
    v_pk_add_f32 v[128:129], v[128:129], v[130:131]
    v_pk_add_f32 v[144:145], v[144:145], v[146:147]
    v_pk_add_f32 v[128:129], v[128:129], v[132:133]
    v_pk_add_f32 v[144:145], v[144:145], v[148:149]
    v_pk_add_f32 v[128:129], v[128:129], v[134:135]
    v_pk_add_f32 v[144:145], v[144:145], v[150:151]
    v_pk_add_f32 v[128:129], v[128:129], v[136:137]
    v_pk_add_f32 v[144:145], v[144:145], v[152:153]
    v_pk_add_f32 v[128:129], v[128:129], v[138:139]
    v_pk_add_f32 v[144:145], v[144:145], v[154:155]
    v_pk_add_f32 v[128:129], v[128:129], v[140:141]
    v_pk_add_f32 v[144:145], v[144:145], v[156:157]
    v_pk_add_f32 v[128:129], v[128:129], v[142:143]
    v_pk_add_f32 v[144:145], v[144:145], v[158:159]
    v_pk_add_f32 v[128:129], v[128:129], v[144:145]
    v_mul_f32 v128, 0x3b000000, v128
    v_mul_f32 v129, 0x3b000000, v129
    v_fma_f32 v129, -v128, v128, v129
    v_max_f32 v129, 0, v129
    v_add_f32 v129, 0x3727c5ac, v129
    v_rcp_f32 v114, v129
    v_sub_f32 v112, 0, v128
    v_sub_f32 v113, 0, v128
    v_mov_b32 v115, v114
    v_add_u32 v13, 40960, v11
    s_waitcnt lgkmcnt(0)
    s_barrier
    ds_read_b32 v16, v13 offset:0
    ds_read_b32 v17, v13 offset:128
    ds_read_b32 v18, v13 offset:256
    ds_read_b32 v19, v13 offset:384
    ds_read_b32 v20, v13 offset:512
    ds_read_b32 v21, v13 offset:640
    ds_read_b32 v22, v13 offset:768
    ds_read_b32 v23, v13 offset:896
    ds_read_b32 v24, v13 offset:1024
    ds_read_b32 v25, v13 offset:1152
    ds_read_b32 v26, v13 offset:1280
    ds_read_b32 v27, v13 offset:1408
    ds_read_b32 v28, v13 offset:1536
    ds_read_b32 v29, v13 offset:1664
    ds_read_b32 v30, v13 offset:1792
    ds_read_b32 v31, v13 offset:1920
    ds_read_b32 v32, v13 offset:2048
    ds_read_b32 v33, v13 offset:2176
    ds_read_b32 v34, v13 offset:2304
    ds_read_b32 v35, v13 offset:2432
    ds_read_b32 v36, v13 offset:2560
    ds_read_b32 v37, v13 offset:2688
    ds_read_b32 v38, v13 offset:2816
    ds_read_b32 v39, v13 offset:2944
    s_add_u32 s38, s38, 4096
    v_add_u32 v12, s38, v11
    v_lshlrev_b32 v13, 4, v3
    v_add_u32 v13, s38, v13
    s_waitcnt lgkmcnt(0)
    v_add_f32 v16, v16, v22
    v_add_f32 v28, v28, v34
    v_add_f32 v17, v17, v23
    v_add_f32 v29, v29, v35
    v_add_f32 v18, v18, v24
    v_add_f32 v30, v30, v36
    v_add_f32 v19, v19, v25
    v_add_f32 v31, v31, v37
    v_add_f32 v20, v20, v26
    v_add_f32 v32, v32, v38
    v_add_f32 v21, v21, v27
    v_add_f32 v33, v33, v39
    v_add_f32 v16, v16, v28
    v_add_f32 v17, v17, v29
    v_add_f32 v18, v18, v30
    v_add_f32 v19, v19, v31
    v_add_f32 v20, v20, v32
    v_add_f32 v21, v21, v33
    ds_write_b32 v12, v16 offset:0
    ds_write_b32 v12, v17 offset:128
    ds_write_b32 v12, v18 offset:256
    ds_write_b32 v12, v19 offset:384
    ds_write_b32 v12, v20 offset:512
    ds_write_b32 v12, v21 offset:640
    s_waitcnt lgkmcnt(0)
    ds_read_b128 v[16:19], v13 offset:0
    ds_read_b128 v[20:23], v13 offset:32
    ds_read_b128 v[24:27], v13 offset:64
    ds_read_b128 v[28:31], v13 offset:96
    ds_read_b128 v[32:35], v13 offset:128
    ds_read_b128 v[36:39], v13 offset:160
    ds_read_b128 v[40:43], v13 offset:192
    ds_read_b128 v[44:47], v13 offset:224
    ds_read_b128 v[48:51], v13 offset:256
    ds_read_b128 v[52:55], v13 offset:288
    ds_read_b128 v[56:59], v13 offset:320
    ds_read_b128 v[60:63], v13 offset:352
    ds_read_b128 v[64:67], v13 offset:384
    ds_read_b128 v[68:71], v13 offset:416
    ds_read_b128 v[72:75], v13 offset:448
    ds_read_b128 v[76:79], v13 offset:480
    ds_read_b128 v[80:83], v13 offset:512
    ds_read_b128 v[84:87], v13 offset:544
    ds_read_b128 v[88:91], v13 offset:576
    ds_read_b128 v[92:95], v13 offset:608
    ds_read_b128 v[96:99], v13 offset:640
    ds_read_b128 v[100:103], v13 offset:672
    ds_read_b128 v[104:107], v13 offset:704
    ds_read_b128 v[108:111], v13 offset:736
    v_add_u32 v11, s47, v2
    v_mul_u32_u24 v11, 2816, v11
    v_lshl_add_u32 v11, v3, 4, v11
    s_mul_i32 s39, s31, 192
    s_add_u32 s39, s39, 4194304
    s_waitcnt lgkmcnt(0)
    v_pk_fma_f32 v[160:161], v[16:17], v[112:113], v[160:161]
    v_pk_fma_f32 v[208:209], v[64:65], v[112:113], v[208:209]
    v_pk_fma_f32 v[162:163], v[18:19], v[112:113], v[162:163]
    v_pk_fma_f32 v[210:211], v[66:67], v[112:113], v[210:211]
    v_pk_fma_f32 v[164:165], v[20:21], v[112:113], v[164:165]
    v_pk_fma_f32 v[212:213], v[68:69], v[112:113], v[212:213]
    v_pk_fma_f32 v[166:167], v[22:23], v[112:113], v[166:167]
    v_pk_fma_f32 v[214:215], v[70:71], v[112:113], v[214:215]
    v_pk_fma_f32 v[168:169], v[24:25], v[112:113], v[168:169]
    v_pk_fma_f32 v[216:217], v[72:73], v[112:113], v[216:217]
    v_pk_fma_f32 v[170:171], v[26:27], v[112:113], v[170:171]
    v_pk_fma_f32 v[218:219], v[74:75], v[112:113], v[218:219]
    v_pk_fma_f32 v[172:173], v[28:29], v[112:113], v[172:173]
    v_pk_fma_f32 v[220:221], v[76:77], v[112:113], v[220:221]
    v_pk_fma_f32 v[174:175], v[30:31], v[112:113], v[174:175]
    v_pk_fma_f32 v[222:223], v[78:79], v[112:113], v[222:223]
    v_pk_mul_f32 v[160:161], v[160:161], v[208:209]
    v_pk_mul_f32 v[162:163], v[162:163], v[210:211]
    v_pk_mul_f32 v[164:165], v[164:165], v[212:213]
    v_pk_mul_f32 v[166:167], v[166:167], v[214:215]
    v_pk_mul_f32 v[168:169], v[168:169], v[216:217]
    v_pk_mul_f32 v[170:171], v[170:171], v[218:219]
    v_pk_mul_f32 v[172:173], v[172:173], v[220:221]
    v_pk_mul_f32 v[174:175], v[174:175], v[222:223]
    v_pk_mul_f32 v[160:161], v[160:161], v[114:115]
    v_pk_mul_f32 v[162:163], v[162:163], v[114:115]
    v_pk_mul_f32 v[164:165], v[164:165], v[114:115]
    v_pk_mul_f32 v[166:167], v[166:167], v[114:115]
    v_pk_mul_f32 v[168:169], v[168:169], v[114:115]
    v_pk_mul_f32 v[170:171], v[170:171], v[114:115]
    v_pk_mul_f32 v[172:173], v[172:173], v[114:115]
    v_pk_mul_f32 v[174:175], v[174:175], v[114:115]
    v_cvt_pk_bf16_f32 v128, v160, v161
    v_cvt_pk_bf16_f32 v129, v162, v163
    v_cvt_pk_bf16_f32 v130, v164, v165
    v_cvt_pk_bf16_f32 v131, v166, v167
    v_cvt_pk_bf16_f32 v132, v168, v169
    v_cvt_pk_bf16_f32 v133, v170, v171
    v_cvt_pk_bf16_f32 v134, v172, v173
    v_cvt_pk_bf16_f32 v135, v174, v175
    s_nop 1
    v_permlane32_swap_b32 v128, v130
    v_permlane32_swap_b32 v129, v131
    v_permlane32_swap_b32 v132, v134
    v_permlane32_swap_b32 v133, v135
    buffer_store_dwordx4 v[128:131], v11, s[16:19], s39 offen offset:0
    buffer_store_dwordx4 v[132:135], v11, s[16:19], s39 offen offset:32
    s_cmp_eq_u32 s31, 14
    s_cbranch_scc1 k3_fin
    v_pk_fma_f32 v[176:177], v[32:33], v[112:113], v[176:177]
    v_pk_fma_f32 v[224:225], v[80:81], v[112:113], v[224:225]
    v_pk_fma_f32 v[178:179], v[34:35], v[112:113], v[178:179]
    v_pk_fma_f32 v[226:227], v[82:83], v[112:113], v[226:227]
    v_pk_fma_f32 v[180:181], v[36:37], v[112:113], v[180:181]
    v_pk_fma_f32 v[228:229], v[84:85], v[112:113], v[228:229]
    v_pk_fma_f32 v[182:183], v[38:39], v[112:113], v[182:183]
    v_pk_fma_f32 v[230:231], v[86:87], v[112:113], v[230:231]
    v_pk_fma_f32 v[184:185], v[40:41], v[112:113], v[184:185]
    v_pk_fma_f32 v[232:233], v[88:89], v[112:113], v[232:233]
    v_pk_fma_f32 v[186:187], v[42:43], v[112:113], v[186:187]
    v_pk_fma_f32 v[234:235], v[90:91], v[112:113], v[234:235]
    v_pk_fma_f32 v[188:189], v[44:45], v[112:113], v[188:189]
    v_pk_fma_f32 v[236:237], v[92:93], v[112:113], v[236:237]
    v_pk_fma_f32 v[190:191], v[46:47], v[112:113], v[190:191]
    v_pk_fma_f32 v[238:239], v[94:95], v[112:113], v[238:239]
    v_pk_mul_f32 v[176:177], v[176:177], v[224:225]
    v_pk_mul_f32 v[178:179], v[178:179], v[226:227]
    v_pk_mul_f32 v[180:181], v[180:181], v[228:229]
    v_pk_mul_f32 v[182:183], v[182:183], v[230:231]
    v_pk_mul_f32 v[184:185], v[184:185], v[232:233]
    v_pk_mul_f32 v[186:187], v[186:187], v[234:235]
    v_pk_mul_f32 v[188:189], v[188:189], v[236:237]
    v_pk_mul_f32 v[190:191], v[190:191], v[238:239]
    v_pk_mul_f32 v[176:177], v[176:177], v[114:115]
    v_pk_mul_f32 v[178:179], v[178:179], v[114:115]
    v_pk_mul_f32 v[180:181], v[180:181], v[114:115]
    v_pk_mul_f32 v[182:183], v[182:183], v[114:115]
    v_pk_mul_f32 v[184:185], v[184:185], v[114:115]
    v_pk_mul_f32 v[186:187], v[186:187], v[114:115]
    v_pk_mul_f32 v[188:189], v[188:189], v[114:115]
    v_pk_mul_f32 v[190:191], v[190:191], v[114:115]
    v_cvt_pk_bf16_f32 v136, v176, v177
    v_cvt_pk_bf16_f32 v137, v178, v179
    v_cvt_pk_bf16_f32 v138, v180, v181
    v_cvt_pk_bf16_f32 v139, v182, v183
    v_cvt_pk_bf16_f32 v140, v184, v185
    v_cvt_pk_bf16_f32 v141, v186, v187
    v_cvt_pk_bf16_f32 v142, v188, v189
    v_cvt_pk_bf16_f32 v143, v190, v191
    s_nop 1
    v_permlane32_swap_b32 v136, v138
    v_permlane32_swap_b32 v137, v139
    v_permlane32_swap_b32 v140, v142
    v_permlane32_swap_b32 v141, v143
    buffer_store_dwordx4 v[136:139], v11, s[16:19], s39 offen offset:64
    buffer_store_dwordx4 v[140:143], v11, s[16:19], s39 offen offset:96
    s_cmp_eq_u32 s31, 14
    s_cbranch_scc1 k3_fin
    v_pk_fma_f32 v[192:193], v[48:49], v[112:113], v[192:193]
    v_pk_fma_f32 v[240:241], v[96:97], v[112:113], v[240:241]
    v_pk_fma_f32 v[194:195], v[50:51], v[112:113], v[194:195]
    v_pk_fma_f32 v[242:243], v[98:99], v[112:113], v[242:243]
    v_pk_fma_f32 v[196:197], v[52:53], v[112:113], v[196:197]
    v_pk_fma_f32 v[244:245], v[100:101], v[112:113], v[244:245]
    v_pk_fma_f32 v[198:199], v[54:55], v[112:113], v[198:199]
    v_pk_fma_f32 v[246:247], v[102:103], v[112:113], v[246:247]
    v_pk_fma_f32 v[200:201], v[56:57], v[112:113], v[200:201]
    v_pk_fma_f32 v[248:249], v[104:105], v[112:113], v[248:249]
    v_pk_fma_f32 v[202:203], v[58:59], v[112:113], v[202:203]
    v_pk_fma_f32 v[250:251], v[106:107], v[112:113], v[250:251]
    v_pk_fma_f32 v[204:205], v[60:61], v[112:113], v[204:205]
    v_pk_fma_f32 v[252:253], v[108:109], v[112:113], v[252:253]
    v_pk_fma_f32 v[206:207], v[62:63], v[112:113], v[206:207]
    v_pk_fma_f32 v[254:255], v[110:111], v[112:113], v[254:255]
    v_pk_mul_f32 v[192:193], v[192:193], v[240:241]
    v_pk_mul_f32 v[194:195], v[194:195], v[242:243]
    v_pk_mul_f32 v[196:197], v[196:197], v[244:245]
    v_pk_mul_f32 v[198:199], v[198:199], v[246:247]
    v_pk_mul_f32 v[200:201], v[200:201], v[248:249]
    v_pk_mul_f32 v[202:203], v[202:203], v[250:251]
    v_pk_mul_f32 v[204:205], v[204:205], v[252:253]
    v_pk_mul_f32 v[206:207], v[206:207], v[254:255]
    v_pk_mul_f32 v[192:193], v[192:193], v[114:115]
    v_pk_mul_f32 v[194:195], v[194:195], v[114:115]
    v_pk_mul_f32 v[196:197], v[196:197], v[114:115]
    v_pk_mul_f32 v[198:199], v[198:199], v[114:115]
    v_pk_mul_f32 v[200:201], v[200:201], v[114:115]
    v_pk_mul_f32 v[202:203], v[202:203], v[114:115]
    v_pk_mul_f32 v[204:205], v[204:205], v[114:115]
    v_pk_mul_f32 v[206:207], v[206:207], v[114:115]
    v_cvt_pk_bf16_f32 v144, v192, v193
    v_cvt_pk_bf16_f32 v145, v194, v195
    v_cvt_pk_bf16_f32 v146, v196, v197
    v_cvt_pk_bf16_f32 v147, v198, v199
    v_cvt_pk_bf16_f32 v148, v200, v201
    v_cvt_pk_bf16_f32 v149, v202, v203
    v_cvt_pk_bf16_f32 v150, v204, v205
    v_cvt_pk_bf16_f32 v151, v206, v207
    s_nop 1
    v_permlane32_swap_b32 v144, v146
    v_permlane32_swap_b32 v145, v147
    v_permlane32_swap_b32 v148, v150
    v_permlane32_swap_b32 v149, v151
    buffer_store_dwordx4 v[144:147], v11, s[16:19], s39 offen offset:128
    buffer_store_dwordx4 v[148:151], v11, s[16:19], s39 offen offset:160
k3_fin:
k3_end:
    s_endpgm
.globl k4_kernel
.p2align 8
.type k4_kernel,@function
k4_kernel:
    s_cmp_ge_u32 s2, 256
    s_cbranch_scc1 k4_end
    s_load_dwordx4 s[4:7], s[0:1], 48
    s_load_dwordx2 s[26:27], s[0:1], 72
    s_and_b32 s28, s2, 7
    s_lshr_b32 s29, s2, 3
    s_lshl_b32 s30, s28, 2
    s_and_b32 s31, s29, 3
    s_add_u32 s30, s30, s31
    s_lshr_b32 s31, s29, 2
    v_and_b32 v1, 63, v0
    v_lshrrev_b32 v8, 6, v0
    v_and_b32 v2, 31, v1
    v_lshrrev_b32 v3, 5, v1
    v_readfirstlane_b32 s32, v8
    s_waitcnt lgkmcnt(0)
    s_mov_b32 s8, s4
    s_and_b32 s9, s5, 0xffff
    s_mov_b32 s10, 1409024
    s_mov_b32 s11, 0x00020000
    s_mov_b32 s12, s6
    s_and_b32 s13, s7, 0xffff
    s_mov_b32 s14, 2097152
    s_mov_b32 s15, 0x00020000
    s_mov_b32 s16, s26
    s_and_b32 s17, s27, 0xffff
    s_mov_b32 s18, 16777216
    s_mov_b32 s19, 0x00020000
    s_and_b32 s33, s32, 1
    s_lshr_b32 s34, s32, 1
    s_lshl_b32 s35, s30, 6
    s_lshl_b32 s36, s33, 5
    s_add_u32 s47, s35, s36
    s_cmp_lg_u32 s32, 4
    s_cbranch_scc1 k4_compute
    v_lshrrev_b32 v8, 3, v1
    v_mul_u32_u24 v4, 1024, v8
    v_bfe_u32 v9, v1, 4, 1
    v_lshlrev_b32 v9, 2, v9
    v_and_b32 v10, 7, v1
    v_xor_b32 v10, v10, v9
    v_lshl_add_u32 v4, v10, 4, v4
    v_lshrrev_b32 v8, 4, v1
    v_mul_u32_u24 v9, 2816, v8
    v_and_b32 v10, 15, v1
    v_xor_b32 v10, v10, v8
    v_xor_b32 v11, 0, v10
    v_lshl_add_u32 v40, v11, 4, v9
    v_xor_b32 v11, 4, v10
    v_lshl_add_u32 v41, v11, 4, v9
    v_xor_b32 v11, 8, v10
    v_lshl_add_u32 v42, v11, 4, v9
    v_xor_b32 v11, 12, v10
    v_lshl_add_u32 v43, v11, 4, v9
    s_mul_i32 s48, s35, 2816
    s_add_u32 s48, s48, 4194304
    s_lshl_b32 s38, s31, 7
    s_mov_b32 m0, 0
    s_add_u32 s36, s48, 0
    buffer_load_dwordx4 v40, s[16:19], s36 offen lds
    s_mov_b32 m0, 16384
    s_add_u32 s36, s38, 0
    buffer_load_dwordx4 v4, s[8:11], s36 offen lds
    s_mov_b32 m0, 1024
    s_add_u32 s36, s48, 11264
    buffer_load_dwordx4 v41, s[16:19], s36 offen lds
    s_mov_b32 m0, 17408
    s_add_u32 s36, s38, 8192
    buffer_load_dwordx4 v4, s[8:11], s36 offen lds
    s_mov_b32 m0, 2048
    s_add_u32 s36, s48, 22528
    buffer_load_dwordx4 v42, s[16:19], s36 offen lds
    s_mov_b32 m0, 18432
    s_add_u32 s36, s38, 16384
    buffer_load_dwordx4 v4, s[8:11], s36 offen lds
    s_mov_b32 m0, 3072
    s_add_u32 s36, s48, 33792
    buffer_load_dwordx4 v43, s[16:19], s36 offen lds
    s_mov_b32 m0, 19456
    s_add_u32 s36, s38, 24576
    buffer_load_dwordx4 v4, s[8:11], s36 offen lds
    s_mov_b32 m0, 4096
    s_add_u32 s36, s48, 45056
    buffer_load_dwordx4 v40, s[16:19], s36 offen lds
    s_mov_b32 m0, 20480
    s_add_u32 s36, s38, 32768
    buffer_load_dwordx4 v4, s[8:11], s36 offen lds
    s_mov_b32 m0, 5120
    s_add_u32 s36, s48, 56320
    buffer_load_dwordx4 v41, s[16:19], s36 offen lds
    s_mov_b32 m0, 21504
    s_add_u32 s36, s38, 40960
    buffer_load_dwordx4 v4, s[8:11], s36 offen lds
    s_mov_b32 m0, 6144
    s_add_u32 s36, s48, 67584
    buffer_load_dwordx4 v42, s[16:19], s36 offen lds
    s_mov_b32 m0, 22528
    s_add_u32 s36, s38, 49152
    buffer_load_dwordx4 v4, s[8:11], s36 offen lds
    s_mov_b32 m0, 7168
    s_add_u32 s36, s48, 78848
    buffer_load_dwordx4 v43, s[16:19], s36 offen lds
    s_mov_b32 m0, 23552
    s_add_u32 s36, s38, 57344
    buffer_load_dwordx4 v4, s[8:11], s36 offen lds
    s_mov_b32 m0, 8192
    s_add_u32 s36, s48, 90112
    buffer_load_dwordx4 v40, s[16:19], s36 offen lds
    s_mov_b32 m0, 24576
    s_add_u32 s36, s38, 65536
    buffer_load_dwordx4 v4, s[8:11], s36 offen lds
    s_mov_b32 m0, 9216
    s_add_u32 s36, s48, 101376
    buffer_load_dwordx4 v41, s[16:19], s36 offen lds
    s_mov_b32 m0, 25600
    s_add_u32 s36, s38, 73728
    buffer_load_dwordx4 v4, s[8:11], s36 offen lds
    s_mov_b32 m0, 10240
    s_add_u32 s36, s48, 112640
    buffer_load_dwordx4 v42, s[16:19], s36 offen lds
    s_mov_b32 m0, 26624
    s_add_u32 s36, s38, 81920
    buffer_load_dwordx4 v4, s[8:11], s36 offen lds
    s_mov_b32 m0, 11264
    s_add_u32 s36, s48, 123904
    buffer_load_dwordx4 v43, s[16:19], s36 offen lds
    s_mov_b32 m0, 27648
    s_add_u32 s36, s38, 90112
    buffer_load_dwordx4 v4, s[8:11], s36 offen lds
    s_mov_b32 m0, 12288
    s_add_u32 s36, s48, 135168
    buffer_load_dwordx4 v40, s[16:19], s36 offen lds
    s_mov_b32 m0, 28672
    s_add_u32 s36, s38, 98304
    buffer_load_dwordx4 v4, s[8:11], s36 offen lds
    s_mov_b32 m0, 13312
    s_add_u32 s36, s48, 146432
    buffer_load_dwordx4 v41, s[16:19], s36 offen lds
    s_mov_b32 m0, 29696
    s_add_u32 s36, s38, 106496
    buffer_load_dwordx4 v4, s[8:11], s36 offen lds
    s_mov_b32 m0, 14336
    s_add_u32 s36, s48, 157696
    buffer_load_dwordx4 v42, s[16:19], s36 offen lds
    s_mov_b32 m0, 30720
    s_add_u32 s36, s38, 114688
    buffer_load_dwordx4 v4, s[8:11], s36 offen lds
    s_mov_b32 m0, 15360
    s_add_u32 s36, s48, 168960
    buffer_load_dwordx4 v43, s[16:19], s36 offen lds
    s_mov_b32 m0, 31744
    s_add_u32 s36, s38, 122880
    buffer_load_dwordx4 v4, s[8:11], s36 offen lds
    s_mov_b32 m0, 32768
    s_add_u32 s36, s48, 256
    buffer_load_dwordx4 v40, s[16:19], s36 offen lds
    s_mov_b32 m0, 49152
    s_add_u32 s36, s38, 131072
    buffer_load_dwordx4 v4, s[8:11], s36 offen lds
    s_mov_b32 m0, 33792
    s_add_u32 s36, s48, 11520
    buffer_load_dwordx4 v41, s[16:19], s36 offen lds
    s_mov_b32 m0, 50176
    s_add_u32 s36, s38, 139264
    buffer_load_dwordx4 v4, s[8:11], s36 offen lds
    s_mov_b32 m0, 34816
    s_add_u32 s36, s48, 22784
    buffer_load_dwordx4 v42, s[16:19], s36 offen lds
    s_mov_b32 m0, 51200
    s_add_u32 s36, s38, 147456
    buffer_load_dwordx4 v4, s[8:11], s36 offen lds
    s_mov_b32 m0, 35840
    s_add_u32 s36, s48, 34048
    buffer_load_dwordx4 v43, s[16:19], s36 offen lds
    s_mov_b32 m0, 52224
    s_add_u32 s36, s38, 155648
    buffer_load_dwordx4 v4, s[8:11], s36 offen lds
    s_mov_b32 m0, 36864
    s_add_u32 s36, s48, 45312
    buffer_load_dwordx4 v40, s[16:19], s36 offen lds
    s_mov_b32 m0, 53248
    s_add_u32 s36, s38, 163840
    buffer_load_dwordx4 v4, s[8:11], s36 offen lds
    s_mov_b32 m0, 37888
    s_add_u32 s36, s48, 56576
    buffer_load_dwordx4 v41, s[16:19], s36 offen lds
    s_mov_b32 m0, 54272
    s_add_u32 s36, s38, 172032
    buffer_load_dwordx4 v4, s[8:11], s36 offen lds
    s_mov_b32 m0, 38912
    s_add_u32 s36, s48, 67840
    buffer_load_dwordx4 v42, s[16:19], s36 offen lds
    s_mov_b32 m0, 55296
    s_add_u32 s36, s38, 180224
    buffer_load_dwordx4 v4, s[8:11], s36 offen lds
    s_mov_b32 m0, 39936
    s_add_u32 s36, s48, 79104
    buffer_load_dwordx4 v43, s[16:19], s36 offen lds
    s_mov_b32 m0, 56320
    s_add_u32 s36, s38, 188416
    buffer_load_dwordx4 v4, s[8:11], s36 offen lds
    s_mov_b32 m0, 40960
    s_add_u32 s36, s48, 90368
    buffer_load_dwordx4 v40, s[16:19], s36 offen lds
    s_mov_b32 m0, 57344
    s_add_u32 s36, s38, 196608
    buffer_load_dwordx4 v4, s[8:11], s36 offen lds
    s_mov_b32 m0, 41984
    s_add_u32 s36, s48, 101632
    buffer_load_dwordx4 v41, s[16:19], s36 offen lds
    s_mov_b32 m0, 58368
    s_add_u32 s36, s38, 204800
    buffer_load_dwordx4 v4, s[8:11], s36 offen lds
    s_mov_b32 m0, 43008
    s_add_u32 s36, s48, 112896
    buffer_load_dwordx4 v42, s[16:19], s36 offen lds
    s_mov_b32 m0, 59392
    s_add_u32 s36, s38, 212992
    buffer_load_dwordx4 v4, s[8:11], s36 offen lds
    s_mov_b32 m0, 44032
    s_add_u32 s36, s48, 124160
    buffer_load_dwordx4 v43, s[16:19], s36 offen lds
    s_mov_b32 m0, 60416
    s_add_u32 s36, s38, 221184
    buffer_load_dwordx4 v4, s[8:11], s36 offen lds
    s_mov_b32 m0, 45056
    s_add_u32 s36, s48, 135424
    buffer_load_dwordx4 v40, s[16:19], s36 offen lds
    s_mov_b32 m0, 61440
    s_add_u32 s36, s38, 229376
    buffer_load_dwordx4 v4, s[8:11], s36 offen lds
    s_mov_b32 m0, 46080
    s_add_u32 s36, s48, 146688
    buffer_load_dwordx4 v41, s[16:19], s36 offen lds
    s_mov_b32 m0, 62464
    s_add_u32 s36, s38, 237568
    buffer_load_dwordx4 v4, s[8:11], s36 offen lds
    s_mov_b32 m0, 47104
    s_add_u32 s36, s48, 157952
    buffer_load_dwordx4 v42, s[16:19], s36 offen lds
    s_mov_b32 m0, 63488
    s_add_u32 s36, s38, 245760
    buffer_load_dwordx4 v4, s[8:11], s36 offen lds
    s_mov_b32 m0, 48128
    s_add_u32 s36, s48, 169216
    buffer_load_dwordx4 v43, s[16:19], s36 offen lds
    s_mov_b32 m0, 64512
    s_add_u32 s36, s38, 253952
    buffer_load_dwordx4 v4, s[8:11], s36 offen lds
    s_waitcnt vmcnt(32)
    s_barrier
    s_mov_b32 m0, 65536
    s_add_u32 s36, s48, 512
    buffer_load_dwordx4 v40, s[16:19], s36 offen lds
    s_mov_b32 m0, 81920
    s_add_u32 s36, s38, 262144
    buffer_load_dwordx4 v4, s[8:11], s36 offen lds
    s_mov_b32 m0, 66560
    s_add_u32 s36, s48, 11776
    buffer_load_dwordx4 v41, s[16:19], s36 offen lds
    s_mov_b32 m0, 82944
    s_add_u32 s36, s38, 270336
    buffer_load_dwordx4 v4, s[8:11], s36 offen lds
    s_mov_b32 m0, 67584
    s_add_u32 s36, s48, 23040
    buffer_load_dwordx4 v42, s[16:19], s36 offen lds
    s_mov_b32 m0, 83968
    s_add_u32 s36, s38, 278528
    buffer_load_dwordx4 v4, s[8:11], s36 offen lds
    s_mov_b32 m0, 68608
    s_add_u32 s36, s48, 34304
    buffer_load_dwordx4 v43, s[16:19], s36 offen lds
    s_mov_b32 m0, 84992
    s_add_u32 s36, s38, 286720
    buffer_load_dwordx4 v4, s[8:11], s36 offen lds
    s_mov_b32 m0, 69632
    s_add_u32 s36, s48, 45568
    buffer_load_dwordx4 v40, s[16:19], s36 offen lds
    s_mov_b32 m0, 86016
    s_add_u32 s36, s38, 294912
    buffer_load_dwordx4 v4, s[8:11], s36 offen lds
    s_mov_b32 m0, 70656
    s_add_u32 s36, s48, 56832
    buffer_load_dwordx4 v41, s[16:19], s36 offen lds
    s_mov_b32 m0, 87040
    s_add_u32 s36, s38, 303104
    buffer_load_dwordx4 v4, s[8:11], s36 offen lds
    s_mov_b32 m0, 71680
    s_add_u32 s36, s48, 68096
    buffer_load_dwordx4 v42, s[16:19], s36 offen lds
    s_mov_b32 m0, 88064
    s_add_u32 s36, s38, 311296
    buffer_load_dwordx4 v4, s[8:11], s36 offen lds
    s_mov_b32 m0, 72704
    s_add_u32 s36, s48, 79360
    buffer_load_dwordx4 v43, s[16:19], s36 offen lds
    s_mov_b32 m0, 89088
    s_add_u32 s36, s38, 319488
    buffer_load_dwordx4 v4, s[8:11], s36 offen lds
    s_mov_b32 m0, 73728
    s_add_u32 s36, s48, 90624
    buffer_load_dwordx4 v40, s[16:19], s36 offen lds
    s_mov_b32 m0, 90112
    s_add_u32 s36, s38, 327680
    buffer_load_dwordx4 v4, s[8:11], s36 offen lds
    s_mov_b32 m0, 74752
    s_add_u32 s36, s48, 101888
    buffer_load_dwordx4 v41, s[16:19], s36 offen lds
    s_mov_b32 m0, 91136
    s_add_u32 s36, s38, 335872
    buffer_load_dwordx4 v4, s[8:11], s36 offen lds
    s_mov_b32 m0, 75776
    s_add_u32 s36, s48, 113152
    buffer_load_dwordx4 v42, s[16:19], s36 offen lds
    s_mov_b32 m0, 92160
    s_add_u32 s36, s38, 344064
    buffer_load_dwordx4 v4, s[8:11], s36 offen lds
    s_mov_b32 m0, 76800
    s_add_u32 s36, s48, 124416
    buffer_load_dwordx4 v43, s[16:19], s36 offen lds
    s_mov_b32 m0, 93184
    s_add_u32 s36, s38, 352256
    buffer_load_dwordx4 v4, s[8:11], s36 offen lds
    s_mov_b32 m0, 77824
    s_add_u32 s36, s48, 135680
    buffer_load_dwordx4 v40, s[16:19], s36 offen lds
    s_mov_b32 m0, 94208
    s_add_u32 s36, s38, 360448
    buffer_load_dwordx4 v4, s[8:11], s36 offen lds
    s_mov_b32 m0, 78848
    s_add_u32 s36, s48, 146944
    buffer_load_dwordx4 v41, s[16:19], s36 offen lds
    s_mov_b32 m0, 95232
    s_add_u32 s36, s38, 368640
    buffer_load_dwordx4 v4, s[8:11], s36 offen lds
    s_mov_b32 m0, 79872
    s_add_u32 s36, s48, 158208
    buffer_load_dwordx4 v42, s[16:19], s36 offen lds
    s_mov_b32 m0, 96256
    s_add_u32 s36, s38, 376832
    buffer_load_dwordx4 v4, s[8:11], s36 offen lds
    s_mov_b32 m0, 80896
    s_add_u32 s36, s48, 169472
    buffer_load_dwordx4 v43, s[16:19], s36 offen lds
    s_mov_b32 m0, 97280
    s_add_u32 s36, s38, 385024
    buffer_load_dwordx4 v4, s[8:11], s36 offen lds
    s_waitcnt vmcnt(32)
    s_barrier
    s_mov_b32 m0, 98304
    s_add_u32 s36, s48, 768
    buffer_load_dwordx4 v40, s[16:19], s36 offen lds
    s_mov_b32 m0, 114688
    s_add_u32 s36, s38, 393216
    buffer_load_dwordx4 v4, s[8:11], s36 offen lds
    s_mov_b32 m0, 99328
    s_add_u32 s36, s48, 12032
    buffer_load_dwordx4 v41, s[16:19], s36 offen lds
    s_mov_b32 m0, 115712
    s_add_u32 s36, s38, 401408
    buffer_load_dwordx4 v4, s[8:11], s36 offen lds
    s_mov_b32 m0, 100352
    s_add_u32 s36, s48, 23296
    buffer_load_dwordx4 v42, s[16:19], s36 offen lds
    s_mov_b32 m0, 116736
    s_add_u32 s36, s38, 409600
    buffer_load_dwordx4 v4, s[8:11], s36 offen lds
    s_mov_b32 m0, 101376
    s_add_u32 s36, s48, 34560
    buffer_load_dwordx4 v43, s[16:19], s36 offen lds
    s_mov_b32 m0, 117760
    s_add_u32 s36, s38, 417792
    buffer_load_dwordx4 v4, s[8:11], s36 offen lds
    s_mov_b32 m0, 102400
    s_add_u32 s36, s48, 45824
    buffer_load_dwordx4 v40, s[16:19], s36 offen lds
    s_mov_b32 m0, 118784
    s_add_u32 s36, s38, 425984
    buffer_load_dwordx4 v4, s[8:11], s36 offen lds
    s_mov_b32 m0, 103424
    s_add_u32 s36, s48, 57088
    buffer_load_dwordx4 v41, s[16:19], s36 offen lds
    s_mov_b32 m0, 119808
    s_add_u32 s36, s38, 434176
    buffer_load_dwordx4 v4, s[8:11], s36 offen lds
    s_mov_b32 m0, 104448
    s_add_u32 s36, s48, 68352
    buffer_load_dwordx4 v42, s[16:19], s36 offen lds
    s_mov_b32 m0, 120832
    s_add_u32 s36, s38, 442368
    buffer_load_dwordx4 v4, s[8:11], s36 offen lds
    s_mov_b32 m0, 105472
    s_add_u32 s36, s48, 79616
    buffer_load_dwordx4 v43, s[16:19], s36 offen lds
    s_mov_b32 m0, 121856
    s_add_u32 s36, s38, 450560
    buffer_load_dwordx4 v4, s[8:11], s36 offen lds
    s_mov_b32 m0, 106496
    s_add_u32 s36, s48, 90880
    buffer_load_dwordx4 v40, s[16:19], s36 offen lds
    s_mov_b32 m0, 122880
    s_add_u32 s36, s38, 458752
    buffer_load_dwordx4 v4, s[8:11], s36 offen lds
    s_mov_b32 m0, 107520
    s_add_u32 s36, s48, 102144
    buffer_load_dwordx4 v41, s[16:19], s36 offen lds
    s_mov_b32 m0, 123904
    s_add_u32 s36, s38, 466944
    buffer_load_dwordx4 v4, s[8:11], s36 offen lds
    s_mov_b32 m0, 108544
    s_add_u32 s36, s48, 113408
    buffer_load_dwordx4 v42, s[16:19], s36 offen lds
    s_mov_b32 m0, 124928
    s_add_u32 s36, s38, 475136
    buffer_load_dwordx4 v4, s[8:11], s36 offen lds
    s_mov_b32 m0, 109568
    s_add_u32 s36, s48, 124672
    buffer_load_dwordx4 v43, s[16:19], s36 offen lds
    s_mov_b32 m0, 125952
    s_add_u32 s36, s38, 483328
    buffer_load_dwordx4 v4, s[8:11], s36 offen lds
    s_mov_b32 m0, 110592
    s_add_u32 s36, s48, 135936
    buffer_load_dwordx4 v40, s[16:19], s36 offen lds
    s_mov_b32 m0, 126976
    s_add_u32 s36, s38, 491520
    buffer_load_dwordx4 v4, s[8:11], s36 offen lds
    s_mov_b32 m0, 111616
    s_add_u32 s36, s48, 147200
    buffer_load_dwordx4 v41, s[16:19], s36 offen lds
    s_mov_b32 m0, 128000
    s_add_u32 s36, s38, 499712
    buffer_load_dwordx4 v4, s[8:11], s36 offen lds
    s_mov_b32 m0, 112640
    s_add_u32 s36, s48, 158464
    buffer_load_dwordx4 v42, s[16:19], s36 offen lds
    s_mov_b32 m0, 129024
    s_add_u32 s36, s38, 507904
    buffer_load_dwordx4 v4, s[8:11], s36 offen lds
    s_mov_b32 m0, 113664
    s_add_u32 s36, s48, 169728
    buffer_load_dwordx4 v43, s[16:19], s36 offen lds
    s_mov_b32 m0, 130048
    s_add_u32 s36, s38, 516096
    buffer_load_dwordx4 v4, s[8:11], s36 offen lds
    s_waitcnt vmcnt(32)
    s_barrier
    s_mov_b32 m0, 0
    s_add_u32 s36, s48, 1024
    buffer_load_dwordx4 v40, s[16:19], s36 offen lds
    s_mov_b32 m0, 16384
    s_add_u32 s36, s38, 524288
    buffer_load_dwordx4 v4, s[8:11], s36 offen lds
    s_mov_b32 m0, 1024
    s_add_u32 s36, s48, 12288
    buffer_load_dwordx4 v41, s[16:19], s36 offen lds
    s_mov_b32 m0, 17408
    s_add_u32 s36, s38, 532480
    buffer_load_dwordx4 v4, s[8:11], s36 offen lds
    s_mov_b32 m0, 2048
    s_add_u32 s36, s48, 23552
    buffer_load_dwordx4 v42, s[16:19], s36 offen lds
    s_mov_b32 m0, 18432
    s_add_u32 s36, s38, 540672
    buffer_load_dwordx4 v4, s[8:11], s36 offen lds
    s_mov_b32 m0, 3072
    s_add_u32 s36, s48, 34816
    buffer_load_dwordx4 v43, s[16:19], s36 offen lds
    s_mov_b32 m0, 19456
    s_add_u32 s36, s38, 548864
    buffer_load_dwordx4 v4, s[8:11], s36 offen lds
    s_mov_b32 m0, 4096
    s_add_u32 s36, s48, 46080
    buffer_load_dwordx4 v40, s[16:19], s36 offen lds
    s_mov_b32 m0, 20480
    s_add_u32 s36, s38, 557056
    buffer_load_dwordx4 v4, s[8:11], s36 offen lds
    s_mov_b32 m0, 5120
    s_add_u32 s36, s48, 57344
    buffer_load_dwordx4 v41, s[16:19], s36 offen lds
    s_mov_b32 m0, 21504
    s_add_u32 s36, s38, 565248
    buffer_load_dwordx4 v4, s[8:11], s36 offen lds
    s_mov_b32 m0, 6144
    s_add_u32 s36, s48, 68608
    buffer_load_dwordx4 v42, s[16:19], s36 offen lds
    s_mov_b32 m0, 22528
    s_add_u32 s36, s38, 573440
    buffer_load_dwordx4 v4, s[8:11], s36 offen lds
    s_mov_b32 m0, 7168
    s_add_u32 s36, s48, 79872
    buffer_load_dwordx4 v43, s[16:19], s36 offen lds
    s_mov_b32 m0, 23552
    s_add_u32 s36, s38, 581632
    buffer_load_dwordx4 v4, s[8:11], s36 offen lds
    s_mov_b32 m0, 8192
    s_add_u32 s36, s48, 91136
    buffer_load_dwordx4 v40, s[16:19], s36 offen lds
    s_mov_b32 m0, 24576
    s_add_u32 s36, s38, 589824
    buffer_load_dwordx4 v4, s[8:11], s36 offen lds
    s_mov_b32 m0, 9216
    s_add_u32 s36, s48, 102400
    buffer_load_dwordx4 v41, s[16:19], s36 offen lds
    s_mov_b32 m0, 25600
    s_add_u32 s36, s38, 598016
    buffer_load_dwordx4 v4, s[8:11], s36 offen lds
    s_mov_b32 m0, 10240
    s_add_u32 s36, s48, 113664
    buffer_load_dwordx4 v42, s[16:19], s36 offen lds
    s_mov_b32 m0, 26624
    s_add_u32 s36, s38, 606208
    buffer_load_dwordx4 v4, s[8:11], s36 offen lds
    s_mov_b32 m0, 11264
    s_add_u32 s36, s48, 124928
    buffer_load_dwordx4 v43, s[16:19], s36 offen lds
    s_mov_b32 m0, 27648
    s_add_u32 s36, s38, 614400
    buffer_load_dwordx4 v4, s[8:11], s36 offen lds
    s_mov_b32 m0, 12288
    s_add_u32 s36, s48, 136192
    buffer_load_dwordx4 v40, s[16:19], s36 offen lds
    s_mov_b32 m0, 28672
    s_add_u32 s36, s38, 622592
    buffer_load_dwordx4 v4, s[8:11], s36 offen lds
    s_mov_b32 m0, 13312
    s_add_u32 s36, s48, 147456
    buffer_load_dwordx4 v41, s[16:19], s36 offen lds
    s_mov_b32 m0, 29696
    s_add_u32 s36, s38, 630784
    buffer_load_dwordx4 v4, s[8:11], s36 offen lds
    s_mov_b32 m0, 14336
    s_add_u32 s36, s48, 158720
    buffer_load_dwordx4 v42, s[16:19], s36 offen lds
    s_mov_b32 m0, 30720
    s_add_u32 s36, s38, 638976
    buffer_load_dwordx4 v4, s[8:11], s36 offen lds
    s_mov_b32 m0, 15360
    s_add_u32 s36, s48, 169984
    buffer_load_dwordx4 v43, s[16:19], s36 offen lds
    s_mov_b32 m0, 31744
    s_add_u32 s36, s38, 647168
    buffer_load_dwordx4 v4, s[8:11], s36 offen lds
    s_waitcnt vmcnt(32)
    s_barrier
    s_mov_b32 m0, 32768
    s_add_u32 s36, s48, 1280
    buffer_load_dwordx4 v40, s[16:19], s36 offen lds
    s_mov_b32 m0, 49152
    s_add_u32 s36, s38, 655360
    buffer_load_dwordx4 v4, s[8:11], s36 offen lds
    s_mov_b32 m0, 33792
    s_add_u32 s36, s48, 12544
    buffer_load_dwordx4 v41, s[16:19], s36 offen lds
    s_mov_b32 m0, 50176
    s_add_u32 s36, s38, 663552
    buffer_load_dwordx4 v4, s[8:11], s36 offen lds
    s_mov_b32 m0, 34816
    s_add_u32 s36, s48, 23808
    buffer_load_dwordx4 v42, s[16:19], s36 offen lds
    s_mov_b32 m0, 51200
    s_add_u32 s36, s38, 671744
    buffer_load_dwordx4 v4, s[8:11], s36 offen lds
    s_mov_b32 m0, 35840
    s_add_u32 s36, s48, 35072
    buffer_load_dwordx4 v43, s[16:19], s36 offen lds
    s_mov_b32 m0, 52224
    s_add_u32 s36, s38, 679936
    buffer_load_dwordx4 v4, s[8:11], s36 offen lds
    s_mov_b32 m0, 36864
    s_add_u32 s36, s48, 46336
    buffer_load_dwordx4 v40, s[16:19], s36 offen lds
    s_mov_b32 m0, 53248
    s_add_u32 s36, s38, 688128
    buffer_load_dwordx4 v4, s[8:11], s36 offen lds
    s_mov_b32 m0, 37888
    s_add_u32 s36, s48, 57600
    buffer_load_dwordx4 v41, s[16:19], s36 offen lds
    s_mov_b32 m0, 54272
    s_add_u32 s36, s38, 696320
    buffer_load_dwordx4 v4, s[8:11], s36 offen lds
    s_mov_b32 m0, 38912
    s_add_u32 s36, s48, 68864
    buffer_load_dwordx4 v42, s[16:19], s36 offen lds
    s_mov_b32 m0, 55296
    s_add_u32 s36, s38, 704512
    buffer_load_dwordx4 v4, s[8:11], s36 offen lds
    s_mov_b32 m0, 39936
    s_add_u32 s36, s48, 80128
    buffer_load_dwordx4 v43, s[16:19], s36 offen lds
    s_mov_b32 m0, 56320
    s_add_u32 s36, s38, 712704
    buffer_load_dwordx4 v4, s[8:11], s36 offen lds
    s_mov_b32 m0, 40960
    s_add_u32 s36, s48, 91392
    buffer_load_dwordx4 v40, s[16:19], s36 offen lds
    s_mov_b32 m0, 57344
    s_add_u32 s36, s38, 720896
    buffer_load_dwordx4 v4, s[8:11], s36 offen lds
    s_mov_b32 m0, 41984
    s_add_u32 s36, s48, 102656
    buffer_load_dwordx4 v41, s[16:19], s36 offen lds
    s_mov_b32 m0, 58368
    s_add_u32 s36, s38, 729088
    buffer_load_dwordx4 v4, s[8:11], s36 offen lds
    s_mov_b32 m0, 43008
    s_add_u32 s36, s48, 113920
    buffer_load_dwordx4 v42, s[16:19], s36 offen lds
    s_mov_b32 m0, 59392
    s_add_u32 s36, s38, 737280
    buffer_load_dwordx4 v4, s[8:11], s36 offen lds
    s_mov_b32 m0, 44032
    s_add_u32 s36, s48, 125184
    buffer_load_dwordx4 v43, s[16:19], s36 offen lds
    s_mov_b32 m0, 60416
    s_add_u32 s36, s38, 745472
    buffer_load_dwordx4 v4, s[8:11], s36 offen lds
    s_mov_b32 m0, 45056
    s_add_u32 s36, s48, 136448
    buffer_load_dwordx4 v40, s[16:19], s36 offen lds
    s_mov_b32 m0, 61440
    s_add_u32 s36, s38, 753664
    buffer_load_dwordx4 v4, s[8:11], s36 offen lds
    s_mov_b32 m0, 46080
    s_add_u32 s36, s48, 147712
    buffer_load_dwordx4 v41, s[16:19], s36 offen lds
    s_mov_b32 m0, 62464
    s_add_u32 s36, s38, 761856
    buffer_load_dwordx4 v4, s[8:11], s36 offen lds
    s_mov_b32 m0, 47104
    s_add_u32 s36, s48, 158976
    buffer_load_dwordx4 v42, s[16:19], s36 offen lds
    s_mov_b32 m0, 63488
    s_add_u32 s36, s38, 770048
    buffer_load_dwordx4 v4, s[8:11], s36 offen lds
    s_mov_b32 m0, 48128
    s_add_u32 s36, s48, 170240
    buffer_load_dwordx4 v43, s[16:19], s36 offen lds
    s_mov_b32 m0, 64512
    s_add_u32 s36, s38, 778240
    buffer_load_dwordx4 v4, s[8:11], s36 offen lds
    s_waitcnt vmcnt(32)
    s_barrier
    s_mov_b32 m0, 65536
    s_add_u32 s36, s48, 1536
    buffer_load_dwordx4 v40, s[16:19], s36 offen lds
    s_mov_b32 m0, 81920
    s_add_u32 s36, s38, 786432
    buffer_load_dwordx4 v4, s[8:11], s36 offen lds
    s_mov_b32 m0, 66560
    s_add_u32 s36, s48, 12800
    buffer_load_dwordx4 v41, s[16:19], s36 offen lds
    s_mov_b32 m0, 82944
    s_add_u32 s36, s38, 794624
    buffer_load_dwordx4 v4, s[8:11], s36 offen lds
    s_mov_b32 m0, 67584
    s_add_u32 s36, s48, 24064
    buffer_load_dwordx4 v42, s[16:19], s36 offen lds
    s_mov_b32 m0, 83968
    s_add_u32 s36, s38, 802816
    buffer_load_dwordx4 v4, s[8:11], s36 offen lds
    s_mov_b32 m0, 68608
    s_add_u32 s36, s48, 35328
    buffer_load_dwordx4 v43, s[16:19], s36 offen lds
    s_mov_b32 m0, 84992
    s_add_u32 s36, s38, 811008
    buffer_load_dwordx4 v4, s[8:11], s36 offen lds
    s_mov_b32 m0, 69632
    s_add_u32 s36, s48, 46592
    buffer_load_dwordx4 v40, s[16:19], s36 offen lds
    s_mov_b32 m0, 86016
    s_add_u32 s36, s38, 819200
    buffer_load_dwordx4 v4, s[8:11], s36 offen lds
    s_mov_b32 m0, 70656
    s_add_u32 s36, s48, 57856
    buffer_load_dwordx4 v41, s[16:19], s36 offen lds
    s_mov_b32 m0, 87040
    s_add_u32 s36, s38, 827392
    buffer_load_dwordx4 v4, s[8:11], s36 offen lds
    s_mov_b32 m0, 71680
    s_add_u32 s36, s48, 69120
    buffer_load_dwordx4 v42, s[16:19], s36 offen lds
    s_mov_b32 m0, 88064
    s_add_u32 s36, s38, 835584
    buffer_load_dwordx4 v4, s[8:11], s36 offen lds
    s_mov_b32 m0, 72704
    s_add_u32 s36, s48, 80384
    buffer_load_dwordx4 v43, s[16:19], s36 offen lds
    s_mov_b32 m0, 89088
    s_add_u32 s36, s38, 843776
    buffer_load_dwordx4 v4, s[8:11], s36 offen lds
    s_mov_b32 m0, 73728
    s_add_u32 s36, s48, 91648
    buffer_load_dwordx4 v40, s[16:19], s36 offen lds
    s_mov_b32 m0, 90112
    s_add_u32 s36, s38, 851968
    buffer_load_dwordx4 v4, s[8:11], s36 offen lds
    s_mov_b32 m0, 74752
    s_add_u32 s36, s48, 102912
    buffer_load_dwordx4 v41, s[16:19], s36 offen lds
    s_mov_b32 m0, 91136
    s_add_u32 s36, s38, 860160
    buffer_load_dwordx4 v4, s[8:11], s36 offen lds
    s_mov_b32 m0, 75776
    s_add_u32 s36, s48, 114176
    buffer_load_dwordx4 v42, s[16:19], s36 offen lds
    s_mov_b32 m0, 92160
    s_add_u32 s36, s38, 868352
    buffer_load_dwordx4 v4, s[8:11], s36 offen lds
    s_mov_b32 m0, 76800
    s_add_u32 s36, s48, 125440
    buffer_load_dwordx4 v43, s[16:19], s36 offen lds
    s_mov_b32 m0, 93184
    s_add_u32 s36, s38, 876544
    buffer_load_dwordx4 v4, s[8:11], s36 offen lds
    s_mov_b32 m0, 77824
    s_add_u32 s36, s48, 136704
    buffer_load_dwordx4 v40, s[16:19], s36 offen lds
    s_mov_b32 m0, 94208
    s_add_u32 s36, s38, 884736
    buffer_load_dwordx4 v4, s[8:11], s36 offen lds
    s_mov_b32 m0, 78848
    s_add_u32 s36, s48, 147968
    buffer_load_dwordx4 v41, s[16:19], s36 offen lds
    s_mov_b32 m0, 95232
    s_add_u32 s36, s38, 892928
    buffer_load_dwordx4 v4, s[8:11], s36 offen lds
    s_mov_b32 m0, 79872
    s_add_u32 s36, s48, 159232
    buffer_load_dwordx4 v42, s[16:19], s36 offen lds
    s_mov_b32 m0, 96256
    s_add_u32 s36, s38, 901120
    buffer_load_dwordx4 v4, s[8:11], s36 offen lds
    s_mov_b32 m0, 80896
    s_add_u32 s36, s48, 170496
    buffer_load_dwordx4 v43, s[16:19], s36 offen lds
    s_mov_b32 m0, 97280
    s_add_u32 s36, s38, 909312
    buffer_load_dwordx4 v4, s[8:11], s36 offen lds
    s_waitcnt vmcnt(32)
    s_barrier
    s_mov_b32 m0, 98304
    s_add_u32 s36, s48, 1792
    buffer_load_dwordx4 v40, s[16:19], s36 offen lds
    s_mov_b32 m0, 114688
    s_add_u32 s36, s38, 917504
    buffer_load_dwordx4 v4, s[8:11], s36 offen lds
    s_mov_b32 m0, 99328
    s_add_u32 s36, s48, 13056
    buffer_load_dwordx4 v41, s[16:19], s36 offen lds
    s_mov_b32 m0, 115712
    s_add_u32 s36, s38, 925696
    buffer_load_dwordx4 v4, s[8:11], s36 offen lds
    s_mov_b32 m0, 100352
    s_add_u32 s36, s48, 24320
    buffer_load_dwordx4 v42, s[16:19], s36 offen lds
    s_mov_b32 m0, 116736
    s_add_u32 s36, s38, 933888
    buffer_load_dwordx4 v4, s[8:11], s36 offen lds
    s_mov_b32 m0, 101376
    s_add_u32 s36, s48, 35584
    buffer_load_dwordx4 v43, s[16:19], s36 offen lds
    s_mov_b32 m0, 117760
    s_add_u32 s36, s38, 942080
    buffer_load_dwordx4 v4, s[8:11], s36 offen lds
    s_mov_b32 m0, 102400
    s_add_u32 s36, s48, 46848
    buffer_load_dwordx4 v40, s[16:19], s36 offen lds
    s_mov_b32 m0, 118784
    s_add_u32 s36, s38, 950272
    buffer_load_dwordx4 v4, s[8:11], s36 offen lds
    s_mov_b32 m0, 103424
    s_add_u32 s36, s48, 58112
    buffer_load_dwordx4 v41, s[16:19], s36 offen lds
    s_mov_b32 m0, 119808
    s_add_u32 s36, s38, 958464
    buffer_load_dwordx4 v4, s[8:11], s36 offen lds
    s_mov_b32 m0, 104448
    s_add_u32 s36, s48, 69376
    buffer_load_dwordx4 v42, s[16:19], s36 offen lds
    s_mov_b32 m0, 120832
    s_add_u32 s36, s38, 966656
    buffer_load_dwordx4 v4, s[8:11], s36 offen lds
    s_mov_b32 m0, 105472
    s_add_u32 s36, s48, 80640
    buffer_load_dwordx4 v43, s[16:19], s36 offen lds
    s_mov_b32 m0, 121856
    s_add_u32 s36, s38, 974848
    buffer_load_dwordx4 v4, s[8:11], s36 offen lds
    s_mov_b32 m0, 106496
    s_add_u32 s36, s48, 91904
    buffer_load_dwordx4 v40, s[16:19], s36 offen lds
    s_mov_b32 m0, 122880
    s_add_u32 s36, s38, 983040
    buffer_load_dwordx4 v4, s[8:11], s36 offen lds
    s_mov_b32 m0, 107520
    s_add_u32 s36, s48, 103168
    buffer_load_dwordx4 v41, s[16:19], s36 offen lds
    s_mov_b32 m0, 123904
    s_add_u32 s36, s38, 991232
    buffer_load_dwordx4 v4, s[8:11], s36 offen lds
    s_mov_b32 m0, 108544
    s_add_u32 s36, s48, 114432
    buffer_load_dwordx4 v42, s[16:19], s36 offen lds
    s_mov_b32 m0, 124928
    s_add_u32 s36, s38, 999424
    buffer_load_dwordx4 v4, s[8:11], s36 offen lds
    s_mov_b32 m0, 109568
    s_add_u32 s36, s48, 125696
    buffer_load_dwordx4 v43, s[16:19], s36 offen lds
    s_mov_b32 m0, 125952
    s_add_u32 s36, s38, 1007616
    buffer_load_dwordx4 v4, s[8:11], s36 offen lds
    s_mov_b32 m0, 110592
    s_add_u32 s36, s48, 136960
    buffer_load_dwordx4 v40, s[16:19], s36 offen lds
    s_mov_b32 m0, 126976
    s_add_u32 s36, s38, 1015808
    buffer_load_dwordx4 v4, s[8:11], s36 offen lds
    s_mov_b32 m0, 111616
    s_add_u32 s36, s48, 148224
    buffer_load_dwordx4 v41, s[16:19], s36 offen lds
    s_mov_b32 m0, 128000
    s_add_u32 s36, s38, 1024000
    buffer_load_dwordx4 v4, s[8:11], s36 offen lds
    s_mov_b32 m0, 112640
    s_add_u32 s36, s48, 159488
    buffer_load_dwordx4 v42, s[16:19], s36 offen lds
    s_mov_b32 m0, 129024
    s_add_u32 s36, s38, 1032192
    buffer_load_dwordx4 v4, s[8:11], s36 offen lds
    s_mov_b32 m0, 113664
    s_add_u32 s36, s48, 170752
    buffer_load_dwordx4 v43, s[16:19], s36 offen lds
    s_mov_b32 m0, 130048
    s_add_u32 s36, s38, 1040384
    buffer_load_dwordx4 v4, s[8:11], s36 offen lds
    s_waitcnt vmcnt(32)
    s_barrier
    s_mov_b32 m0, 0
    s_add_u32 s36, s48, 2048
    buffer_load_dwordx4 v40, s[16:19], s36 offen lds
    s_mov_b32 m0, 16384
    s_add_u32 s36, s38, 1048576
    buffer_load_dwordx4 v4, s[8:11], s36 offen lds
    s_mov_b32 m0, 1024
    s_add_u32 s36, s48, 13312
    buffer_load_dwordx4 v41, s[16:19], s36 offen lds
    s_mov_b32 m0, 17408
    s_add_u32 s36, s38, 1056768
    buffer_load_dwordx4 v4, s[8:11], s36 offen lds
    s_mov_b32 m0, 2048
    s_add_u32 s36, s48, 24576
    buffer_load_dwordx4 v42, s[16:19], s36 offen lds
    s_mov_b32 m0, 18432
    s_add_u32 s36, s38, 1064960
    buffer_load_dwordx4 v4, s[8:11], s36 offen lds
    s_mov_b32 m0, 3072
    s_add_u32 s36, s48, 35840
    buffer_load_dwordx4 v43, s[16:19], s36 offen lds
    s_mov_b32 m0, 19456
    s_add_u32 s36, s38, 1073152
    buffer_load_dwordx4 v4, s[8:11], s36 offen lds
    s_mov_b32 m0, 4096
    s_add_u32 s36, s48, 47104
    buffer_load_dwordx4 v40, s[16:19], s36 offen lds
    s_mov_b32 m0, 20480
    s_add_u32 s36, s38, 1081344
    buffer_load_dwordx4 v4, s[8:11], s36 offen lds
    s_mov_b32 m0, 5120
    s_add_u32 s36, s48, 58368
    buffer_load_dwordx4 v41, s[16:19], s36 offen lds
    s_mov_b32 m0, 21504
    s_add_u32 s36, s38, 1089536
    buffer_load_dwordx4 v4, s[8:11], s36 offen lds
    s_mov_b32 m0, 6144
    s_add_u32 s36, s48, 69632
    buffer_load_dwordx4 v42, s[16:19], s36 offen lds
    s_mov_b32 m0, 22528
    s_add_u32 s36, s38, 1097728
    buffer_load_dwordx4 v4, s[8:11], s36 offen lds
    s_mov_b32 m0, 7168
    s_add_u32 s36, s48, 80896
    buffer_load_dwordx4 v43, s[16:19], s36 offen lds
    s_mov_b32 m0, 23552
    s_add_u32 s36, s38, 1105920
    buffer_load_dwordx4 v4, s[8:11], s36 offen lds
    s_mov_b32 m0, 8192
    s_add_u32 s36, s48, 92160
    buffer_load_dwordx4 v40, s[16:19], s36 offen lds
    s_mov_b32 m0, 24576
    s_add_u32 s36, s38, 1114112
    buffer_load_dwordx4 v4, s[8:11], s36 offen lds
    s_mov_b32 m0, 9216
    s_add_u32 s36, s48, 103424
    buffer_load_dwordx4 v41, s[16:19], s36 offen lds
    s_mov_b32 m0, 25600
    s_add_u32 s36, s38, 1122304
    buffer_load_dwordx4 v4, s[8:11], s36 offen lds
    s_mov_b32 m0, 10240
    s_add_u32 s36, s48, 114688
    buffer_load_dwordx4 v42, s[16:19], s36 offen lds
    s_mov_b32 m0, 26624
    s_add_u32 s36, s38, 1130496
    buffer_load_dwordx4 v4, s[8:11], s36 offen lds
    s_mov_b32 m0, 11264
    s_add_u32 s36, s48, 125952
    buffer_load_dwordx4 v43, s[16:19], s36 offen lds
    s_mov_b32 m0, 27648
    s_add_u32 s36, s38, 1138688
    buffer_load_dwordx4 v4, s[8:11], s36 offen lds
    s_mov_b32 m0, 12288
    s_add_u32 s36, s48, 137216
    buffer_load_dwordx4 v40, s[16:19], s36 offen lds
    s_mov_b32 m0, 28672
    s_add_u32 s36, s38, 1146880
    buffer_load_dwordx4 v4, s[8:11], s36 offen lds
    s_mov_b32 m0, 13312
    s_add_u32 s36, s48, 148480
    buffer_load_dwordx4 v41, s[16:19], s36 offen lds
    s_mov_b32 m0, 29696
    s_add_u32 s36, s38, 1155072
    buffer_load_dwordx4 v4, s[8:11], s36 offen lds
    s_mov_b32 m0, 14336
    s_add_u32 s36, s48, 159744
    buffer_load_dwordx4 v42, s[16:19], s36 offen lds
    s_mov_b32 m0, 30720
    s_add_u32 s36, s38, 1163264
    buffer_load_dwordx4 v4, s[8:11], s36 offen lds
    s_mov_b32 m0, 15360
    s_add_u32 s36, s48, 171008
    buffer_load_dwordx4 v43, s[16:19], s36 offen lds
    s_mov_b32 m0, 31744
    s_add_u32 s36, s38, 1171456
    buffer_load_dwordx4 v4, s[8:11], s36 offen lds
    s_waitcnt vmcnt(32)
    s_barrier
    s_mov_b32 m0, 32768
    s_add_u32 s36, s48, 2304
    buffer_load_dwordx4 v40, s[16:19], s36 offen lds
    s_mov_b32 m0, 49152
    s_add_u32 s36, s38, 1179648
    buffer_load_dwordx4 v4, s[8:11], s36 offen lds
    s_mov_b32 m0, 33792
    s_add_u32 s36, s48, 13568
    buffer_load_dwordx4 v41, s[16:19], s36 offen lds
    s_mov_b32 m0, 50176
    s_add_u32 s36, s38, 1187840
    buffer_load_dwordx4 v4, s[8:11], s36 offen lds
    s_mov_b32 m0, 34816
    s_add_u32 s36, s48, 24832
    buffer_load_dwordx4 v42, s[16:19], s36 offen lds
    s_mov_b32 m0, 51200
    s_add_u32 s36, s38, 1196032
    buffer_load_dwordx4 v4, s[8:11], s36 offen lds
    s_mov_b32 m0, 35840
    s_add_u32 s36, s48, 36096
    buffer_load_dwordx4 v43, s[16:19], s36 offen lds
    s_mov_b32 m0, 52224
    s_add_u32 s36, s38, 1204224
    buffer_load_dwordx4 v4, s[8:11], s36 offen lds
    s_mov_b32 m0, 36864
    s_add_u32 s36, s48, 47360
    buffer_load_dwordx4 v40, s[16:19], s36 offen lds
    s_mov_b32 m0, 53248
    s_add_u32 s36, s38, 1212416
    buffer_load_dwordx4 v4, s[8:11], s36 offen lds
    s_mov_b32 m0, 37888
    s_add_u32 s36, s48, 58624
    buffer_load_dwordx4 v41, s[16:19], s36 offen lds
    s_mov_b32 m0, 54272
    s_add_u32 s36, s38, 1220608
    buffer_load_dwordx4 v4, s[8:11], s36 offen lds
    s_mov_b32 m0, 38912
    s_add_u32 s36, s48, 69888
    buffer_load_dwordx4 v42, s[16:19], s36 offen lds
    s_mov_b32 m0, 55296
    s_add_u32 s36, s38, 1228800
    buffer_load_dwordx4 v4, s[8:11], s36 offen lds
    s_mov_b32 m0, 39936
    s_add_u32 s36, s48, 81152
    buffer_load_dwordx4 v43, s[16:19], s36 offen lds
    s_mov_b32 m0, 56320
    s_add_u32 s36, s38, 1236992
    buffer_load_dwordx4 v4, s[8:11], s36 offen lds
    s_mov_b32 m0, 40960
    s_add_u32 s36, s48, 92416
    buffer_load_dwordx4 v40, s[16:19], s36 offen lds
    s_mov_b32 m0, 57344
    s_add_u32 s36, s38, 1245184
    buffer_load_dwordx4 v4, s[8:11], s36 offen lds
    s_mov_b32 m0, 41984
    s_add_u32 s36, s48, 103680
    buffer_load_dwordx4 v41, s[16:19], s36 offen lds
    s_mov_b32 m0, 58368
    s_add_u32 s36, s38, 1253376
    buffer_load_dwordx4 v4, s[8:11], s36 offen lds
    s_mov_b32 m0, 43008
    s_add_u32 s36, s48, 114944
    buffer_load_dwordx4 v42, s[16:19], s36 offen lds
    s_mov_b32 m0, 59392
    s_add_u32 s36, s38, 1261568
    buffer_load_dwordx4 v4, s[8:11], s36 offen lds
    s_mov_b32 m0, 44032
    s_add_u32 s36, s48, 126208
    buffer_load_dwordx4 v43, s[16:19], s36 offen lds
    s_mov_b32 m0, 60416
    s_add_u32 s36, s38, 1269760
    buffer_load_dwordx4 v4, s[8:11], s36 offen lds
    s_mov_b32 m0, 45056
    s_add_u32 s36, s48, 137472
    buffer_load_dwordx4 v40, s[16:19], s36 offen lds
    s_mov_b32 m0, 61440
    s_add_u32 s36, s38, 1277952
    buffer_load_dwordx4 v4, s[8:11], s36 offen lds
    s_mov_b32 m0, 46080
    s_add_u32 s36, s48, 148736
    buffer_load_dwordx4 v41, s[16:19], s36 offen lds
    s_mov_b32 m0, 62464
    s_add_u32 s36, s38, 1286144
    buffer_load_dwordx4 v4, s[8:11], s36 offen lds
    s_mov_b32 m0, 47104
    s_add_u32 s36, s48, 160000
    buffer_load_dwordx4 v42, s[16:19], s36 offen lds
    s_mov_b32 m0, 63488
    s_add_u32 s36, s38, 1294336
    buffer_load_dwordx4 v4, s[8:11], s36 offen lds
    s_mov_b32 m0, 48128
    s_add_u32 s36, s48, 171264
    buffer_load_dwordx4 v43, s[16:19], s36 offen lds
    s_mov_b32 m0, 64512
    s_add_u32 s36, s38, 1302528
    buffer_load_dwordx4 v4, s[8:11], s36 offen lds
    s_waitcnt vmcnt(32)
    s_barrier
    s_mov_b32 m0, 65536
    s_add_u32 s36, s48, 2560
    buffer_load_dwordx4 v40, s[16:19], s36 offen lds
    s_mov_b32 m0, 81920
    s_add_u32 s36, s38, 1310720
    buffer_load_dwordx4 v4, s[8:11], s36 offen lds
    s_mov_b32 m0, 66560
    s_add_u32 s36, s48, 13824
    buffer_load_dwordx4 v41, s[16:19], s36 offen lds
    s_mov_b32 m0, 82944
    s_add_u32 s36, s38, 1318912
    buffer_load_dwordx4 v4, s[8:11], s36 offen lds
    s_mov_b32 m0, 67584
    s_add_u32 s36, s48, 25088
    buffer_load_dwordx4 v42, s[16:19], s36 offen lds
    s_mov_b32 m0, 83968
    s_add_u32 s36, s38, 1327104
    buffer_load_dwordx4 v4, s[8:11], s36 offen lds
    s_mov_b32 m0, 68608
    s_add_u32 s36, s48, 36352
    buffer_load_dwordx4 v43, s[16:19], s36 offen lds
    s_mov_b32 m0, 84992
    s_add_u32 s36, s38, 1335296
    buffer_load_dwordx4 v4, s[8:11], s36 offen lds
    s_mov_b32 m0, 69632
    s_add_u32 s36, s48, 47616
    buffer_load_dwordx4 v40, s[16:19], s36 offen lds
    s_mov_b32 m0, 86016
    s_add_u32 s36, s38, 1343488
    buffer_load_dwordx4 v4, s[8:11], s36 offen lds
    s_mov_b32 m0, 70656
    s_add_u32 s36, s48, 58880
    buffer_load_dwordx4 v41, s[16:19], s36 offen lds
    s_mov_b32 m0, 87040
    s_add_u32 s36, s38, 1351680
    buffer_load_dwordx4 v4, s[8:11], s36 offen lds
    s_mov_b32 m0, 71680
    s_add_u32 s36, s48, 70144
    buffer_load_dwordx4 v42, s[16:19], s36 offen lds
    s_mov_b32 m0, 88064
    s_add_u32 s36, s38, 1359872
    buffer_load_dwordx4 v4, s[8:11], s36 offen lds
    s_mov_b32 m0, 72704
    s_add_u32 s36, s48, 81408
    buffer_load_dwordx4 v43, s[16:19], s36 offen lds
    s_mov_b32 m0, 89088
    s_add_u32 s36, s38, 1368064
    buffer_load_dwordx4 v4, s[8:11], s36 offen lds
    s_mov_b32 m0, 73728
    s_add_u32 s36, s48, 92672
    buffer_load_dwordx4 v40, s[16:19], s36 offen lds
    s_mov_b32 m0, 90112
    s_add_u32 s36, s38, 1376256
    buffer_load_dwordx4 v4, s[8:11], s36 offen lds
    s_mov_b32 m0, 74752
    s_add_u32 s36, s48, 103936
    buffer_load_dwordx4 v41, s[16:19], s36 offen lds
    s_mov_b32 m0, 91136
    s_add_u32 s36, s38, 1384448
    buffer_load_dwordx4 v4, s[8:11], s36 offen lds
    s_mov_b32 m0, 75776
    s_add_u32 s36, s48, 115200
    buffer_load_dwordx4 v42, s[16:19], s36 offen lds
    s_mov_b32 m0, 92160
    s_add_u32 s36, s38, 1392640
    buffer_load_dwordx4 v4, s[8:11], s36 offen lds
    s_mov_b32 m0, 76800
    s_add_u32 s36, s48, 126464
    buffer_load_dwordx4 v43, s[16:19], s36 offen lds
    s_mov_b32 m0, 93184
    s_add_u32 s36, s38, 1400832
    buffer_load_dwordx4 v4, s[8:11], s36 offen lds
    s_mov_b32 m0, 77824
    s_add_u32 s36, s48, 137728
    buffer_load_dwordx4 v40, s[16:19], s36 offen lds
    s_mov_b32 m0, 94208
    s_add_u32 s36, s38, 1409024
    buffer_load_dwordx4 v4, s[8:11], s36 offen lds
    s_mov_b32 m0, 78848
    s_add_u32 s36, s48, 148992
    buffer_load_dwordx4 v41, s[16:19], s36 offen lds
    s_mov_b32 m0, 95232
    s_add_u32 s36, s38, 1417216
    buffer_load_dwordx4 v4, s[8:11], s36 offen lds
    s_mov_b32 m0, 79872
    s_add_u32 s36, s48, 160256
    buffer_load_dwordx4 v42, s[16:19], s36 offen lds
    s_mov_b32 m0, 96256
    s_add_u32 s36, s38, 1425408
    buffer_load_dwordx4 v4, s[8:11], s36 offen lds
    s_mov_b32 m0, 80896
    s_add_u32 s36, s48, 171520
    buffer_load_dwordx4 v43, s[16:19], s36 offen lds
    s_mov_b32 m0, 97280
    s_add_u32 s36, s38, 1433600
    buffer_load_dwordx4 v4, s[8:11], s36 offen lds
    s_waitcnt vmcnt(32)
    s_barrier
    s_waitcnt vmcnt(0)
    s_barrier
    s_endpgm
k4_compute:
    v_add_u32 v7, s47, v2
    v_lshlrev_b32 v7, 10, v7
    v_lshl_add_u32 v7, v3, 3, v7
    s_lshl_b32 s40, s31, 7
    s_lshl_b32 s39, s34, 6
    s_add_u32 s40, s40, s39
    s_add_u32 s43, s40, 2097152
    buffer_load_dwordx2 v[16:17], v7, s[16:19], s43 offen offset:0
    buffer_load_dwordx2 v[18:19], v7, s[16:19], s43 offen offset:16
    buffer_load_dwordx2 v[20:21], v7, s[16:19], s43 offen offset:32
    buffer_load_dwordx2 v[22:23], v7, s[16:19], s43 offen offset:48
    v_lshrrev_b32 v8, 5, v1
    v_lshlrev_b32 v8, 3, v8
    v_bfe_u32 v9, v1, 2, 2
    v_add_u32 v8, v8, v9
    v_lshlrev_b32 v44, 7, v8
    v_bfe_u32 v8, v1, 4, 1
    v_lshlrev_b32 v8, 1, v8
    v_bfe_u32 v9, v1, 1, 1
    v_add_u32 v8, v8, v9
    s_lshl_b32 s60, s34, 2
    v_add_u32 v8, s60, v8
    v_bfe_u32 v9, v1, 3, 1
    v_lshlrev_b32 v9, 2, v9
    v_xor_b32 v8, v8, v9
    v_lshl_add_u32 v44, v8, 4, v44
    v_and_b32 v8, 1, v1
    v_lshl_add_u32 v44, v8, 3, v44
    v_add_u32 v45, 32768, v44
    v_add_u32 v46, 65536, v44
    v_add_u32 v47, 98304, v44
    v_add_u32 v8, s36, v2
    v_and_b32 v9, 15, v8
    v_xor_b32 v9, v9, v3
    v_lshlrev_b32 v8, 8, v8
    v_xor_b32 v10, 0, v9
    v_lshl_add_u32 v48, v10, 4, v8
    v_add_u32 v56, 32768, v48
    v_add_u32 v64, 65536, v48
    v_add_u32 v72, 98304, v48
    v_xor_b32 v10, 2, v9
    v_lshl_add_u32 v49, v10, 4, v8
    v_add_u32 v57, 32768, v49
    v_add_u32 v65, 65536, v49
    v_add_u32 v73, 98304, v49
    v_xor_b32 v10, 4, v9
    v_lshl_add_u32 v50, v10, 4, v8
    v_add_u32 v58, 32768, v50
    v_add_u32 v66, 65536, v50
    v_add_u32 v74, 98304, v50
    v_xor_b32 v10, 6, v9
    v_lshl_add_u32 v51, v10, 4, v8
    v_add_u32 v59, 32768, v51
    v_add_u32 v67, 65536, v51
    v_add_u32 v75, 98304, v51
    v_xor_b32 v10, 8, v9
    v_lshl_add_u32 v52, v10, 4, v8
    v_add_u32 v60, 32768, v52
    v_add_u32 v68, 65536, v52
    v_add_u32 v76, 98304, v52
    v_xor_b32 v10, 10, v9
    v_lshl_add_u32 v53, v10, 4, v8
    v_add_u32 v61, 32768, v53
    v_add_u32 v69, 65536, v53
    v_add_u32 v77, 98304, v53
    v_xor_b32 v10, 12, v9
    v_lshl_add_u32 v54, v10, 4, v8
    v_add_u32 v62, 32768, v54
    v_add_u32 v70, 65536, v54
    v_add_u32 v78, 98304, v54
    v_xor_b32 v10, 14, v9
    v_lshl_add_u32 v55, v10, 4, v8
    v_add_u32 v63, 32768, v55
    v_add_u32 v71, 65536, v55
    v_add_u32 v79, 98304, v55
    v_mov_b32 v112, 0
    v_mov_b32 v113, 0
    v_mov_b32 v114, 0
    v_mov_b32 v115, 0
    v_mov_b32 v116, 0
    v_mov_b32 v117, 0
    v_mov_b32 v118, 0
    v_mov_b32 v119, 0
    v_mov_b32 v120, 0
    v_mov_b32 v121, 0
    v_mov_b32 v122, 0
    v_mov_b32 v123, 0
    v_mov_b32 v124, 0
    v_mov_b32 v125, 0
    v_mov_b32 v126, 0
    v_mov_b32 v127, 0
    s_barrier
    ds_read_b128 v[32:35], v48
    ds_read_b64_tr_b16 v[24:25], v44 offset:16384
    ds_read_b64_tr_b16 v[26:27], v44 offset:16896
    ds_read_b128 v[36:39], v49
    ds_read_b64_tr_b16 v[28:29], v44 offset:18432
    ds_read_b64_tr_b16 v[30:31], v44 offset:18944
    s_waitcnt lgkmcnt(3)
    v_mfma_f32_32x32x16_bf16 v[112:127], v[24:27], v[32:35], v[112:127]
    ds_read_b128 v[32:35], v50
    ds_read_b64_tr_b16 v[24:25], v44 offset:20480
    ds_read_b64_tr_b16 v[26:27], v44 offset:20992
    s_waitcnt lgkmcnt(3)
    v_mfma_f32_32x32x16_bf16 v[112:127], v[28:31], v[36:39], v[112:127]
    ds_read_b128 v[36:39], v51
    ds_read_b64_tr_b16 v[28:29], v44 offset:22528
    ds_read_b64_tr_b16 v[30:31], v44 offset:23040
    s_waitcnt lgkmcnt(3)
    v_mfma_f32_32x32x16_bf16 v[112:127], v[24:27], v[32:35], v[112:127]
    ds_read_b128 v[32:35], v52
    ds_read_b64_tr_b16 v[24:25], v44 offset:24576
    ds_read_b64_tr_b16 v[26:27], v44 offset:25088
    s_waitcnt lgkmcnt(3)
    v_mfma_f32_32x32x16_bf16 v[112:127], v[28:31], v[36:39], v[112:127]
    ds_read_b128 v[36:39], v53
    ds_read_b64_tr_b16 v[28:29], v44 offset:26624
    ds_read_b64_tr_b16 v[30:31], v44 offset:27136
    s_waitcnt lgkmcnt(3)
    v_mfma_f32_32x32x16_bf16 v[112:127], v[24:27], v[32:35], v[112:127]
    ds_read_b128 v[32:35], v54
    ds_read_b64_tr_b16 v[24:25], v44 offset:28672
    ds_read_b64_tr_b16 v[26:27], v44 offset:29184
    s_waitcnt lgkmcnt(3)
    v_mfma_f32_32x32x16_bf16 v[112:127], v[28:31], v[36:39], v[112:127]
    ds_read_b128 v[36:39], v55
    ds_read_b64_tr_b16 v[28:29], v44 offset:30720
    ds_read_b64_tr_b16 v[30:31], v44 offset:31232
    s_waitcnt lgkmcnt(3)
    v_mfma_f32_32x32x16_bf16 v[112:127], v[24:27], v[32:35], v[112:127]
    s_waitcnt lgkmcnt(0)
    s_barrier
    ds_read_b128 v[32:35], v56
    ds_read_b64_tr_b16 v[24:25], v45 offset:16384
    ds_read_b64_tr_b16 v[26:27], v45 offset:16896
    v_mfma_f32_32x32x16_bf16 v[112:127], v[28:31], v[36:39], v[112:127]
    ds_read_b128 v[36:39], v57
    ds_read_b64_tr_b16 v[28:29], v45 offset:18432
    ds_read_b64_tr_b16 v[30:31], v45 offset:18944
    s_waitcnt lgkmcnt(3)
    v_mfma_f32_32x32x16_bf16 v[112:127], v[24:27], v[32:35], v[112:127]
    ds_read_b128 v[32:35], v58
    ds_read_b64_tr_b16 v[24:25], v45 offset:20480
    ds_read_b64_tr_b16 v[26:27], v45 offset:20992
    s_waitcnt lgkmcnt(3)
    v_mfma_f32_32x32x16_bf16 v[112:127], v[28:31], v[36:39], v[112:127]
    ds_read_b128 v[36:39], v59
    ds_read_b64_tr_b16 v[28:29], v45 offset:22528
    ds_read_b64_tr_b16 v[30:31], v45 offset:23040
    s_waitcnt lgkmcnt(3)
    v_mfma_f32_32x32x16_bf16 v[112:127], v[24:27], v[32:35], v[112:127]
    ds_read_b128 v[32:35], v60
    ds_read_b64_tr_b16 v[24:25], v45 offset:24576
    ds_read_b64_tr_b16 v[26:27], v45 offset:25088
    s_waitcnt lgkmcnt(3)
    v_mfma_f32_32x32x16_bf16 v[112:127], v[28:31], v[36:39], v[112:127]
    ds_read_b128 v[36:39], v61
    ds_read_b64_tr_b16 v[28:29], v45 offset:26624
    ds_read_b64_tr_b16 v[30:31], v45 offset:27136
    s_waitcnt lgkmcnt(3)
    v_mfma_f32_32x32x16_bf16 v[112:127], v[24:27], v[32:35], v[112:127]
    ds_read_b128 v[32:35], v62
    ds_read_b64_tr_b16 v[24:25], v45 offset:28672
    ds_read_b64_tr_b16 v[26:27], v45 offset:29184
    s_waitcnt lgkmcnt(3)
    v_mfma_f32_32x32x16_bf16 v[112:127], v[28:31], v[36:39], v[112:127]
    ds_read_b128 v[36:39], v63
    ds_read_b64_tr_b16 v[28:29], v45 offset:30720
    ds_read_b64_tr_b16 v[30:31], v45 offset:31232
    s_waitcnt lgkmcnt(3)
    v_mfma_f32_32x32x16_bf16 v[112:127], v[24:27], v[32:35], v[112:127]
    s_waitcnt lgkmcnt(0)
    s_barrier
    ds_read_b128 v[32:35], v64
    ds_read_b64_tr_b16 v[24:25], v46 offset:16384
    ds_read_b64_tr_b16 v[26:27], v46 offset:16896
    v_mfma_f32_32x32x16_bf16 v[112:127], v[28:31], v[36:39], v[112:127]
    ds_read_b128 v[36:39], v65
    ds_read_b64_tr_b16 v[28:29], v46 offset:18432
    ds_read_b64_tr_b16 v[30:31], v46 offset:18944
    s_waitcnt lgkmcnt(3)
    v_mfma_f32_32x32x16_bf16 v[112:127], v[24:27], v[32:35], v[112:127]
    ds_read_b128 v[32:35], v66
    ds_read_b64_tr_b16 v[24:25], v46 offset:20480
    ds_read_b64_tr_b16 v[26:27], v46 offset:20992
    s_waitcnt lgkmcnt(3)
    v_mfma_f32_32x32x16_bf16 v[112:127], v[28:31], v[36:39], v[112:127]
    ds_read_b128 v[36:39], v67
    ds_read_b64_tr_b16 v[28:29], v46 offset:22528
    ds_read_b64_tr_b16 v[30:31], v46 offset:23040
    s_waitcnt lgkmcnt(3)
    v_mfma_f32_32x32x16_bf16 v[112:127], v[24:27], v[32:35], v[112:127]
    ds_read_b128 v[32:35], v68
    ds_read_b64_tr_b16 v[24:25], v46 offset:24576
    ds_read_b64_tr_b16 v[26:27], v46 offset:25088
    s_waitcnt lgkmcnt(3)
    v_mfma_f32_32x32x16_bf16 v[112:127], v[28:31], v[36:39], v[112:127]
    ds_read_b128 v[36:39], v69
    ds_read_b64_tr_b16 v[28:29], v46 offset:26624
    ds_read_b64_tr_b16 v[30:31], v46 offset:27136
    s_waitcnt lgkmcnt(3)
    v_mfma_f32_32x32x16_bf16 v[112:127], v[24:27], v[32:35], v[112:127]
    ds_read_b128 v[32:35], v70
    ds_read_b64_tr_b16 v[24:25], v46 offset:28672
    ds_read_b64_tr_b16 v[26:27], v46 offset:29184
    s_waitcnt lgkmcnt(3)
    v_mfma_f32_32x32x16_bf16 v[112:127], v[28:31], v[36:39], v[112:127]
    ds_read_b128 v[36:39], v71
    ds_read_b64_tr_b16 v[28:29], v46 offset:30720
    ds_read_b64_tr_b16 v[30:31], v46 offset:31232
    s_waitcnt lgkmcnt(3)
    v_mfma_f32_32x32x16_bf16 v[112:127], v[24:27], v[32:35], v[112:127]
    s_waitcnt lgkmcnt(0)
    s_barrier
    ds_read_b128 v[32:35], v72
    ds_read_b64_tr_b16 v[24:25], v47 offset:16384
    ds_read_b64_tr_b16 v[26:27], v47 offset:16896
    v_mfma_f32_32x32x16_bf16 v[112:127], v[28:31], v[36:39], v[112:127]
    ds_read_b128 v[36:39], v73
    ds_read_b64_tr_b16 v[28:29], v47 offset:18432
    ds_read_b64_tr_b16 v[30:31], v47 offset:18944
    s_waitcnt lgkmcnt(3)
    v_mfma_f32_32x32x16_bf16 v[112:127], v[24:27], v[32:35], v[112:127]
    ds_read_b128 v[32:35], v74
    ds_read_b64_tr_b16 v[24:25], v47 offset:20480
    ds_read_b64_tr_b16 v[26:27], v47 offset:20992
    s_waitcnt lgkmcnt(3)
    v_mfma_f32_32x32x16_bf16 v[112:127], v[28:31], v[36:39], v[112:127]
    ds_read_b128 v[36:39], v75
    ds_read_b64_tr_b16 v[28:29], v47 offset:22528
    ds_read_b64_tr_b16 v[30:31], v47 offset:23040
    s_waitcnt lgkmcnt(3)
    v_mfma_f32_32x32x16_bf16 v[112:127], v[24:27], v[32:35], v[112:127]
    ds_read_b128 v[32:35], v76
    ds_read_b64_tr_b16 v[24:25], v47 offset:24576
    ds_read_b64_tr_b16 v[26:27], v47 offset:25088
    s_waitcnt lgkmcnt(3)
    v_mfma_f32_32x32x16_bf16 v[112:127], v[28:31], v[36:39], v[112:127]
    ds_read_b128 v[36:39], v77
    ds_read_b64_tr_b16 v[28:29], v47 offset:26624
    ds_read_b64_tr_b16 v[30:31], v47 offset:27136
    s_waitcnt lgkmcnt(3)
    v_mfma_f32_32x32x16_bf16 v[112:127], v[24:27], v[32:35], v[112:127]
    ds_read_b128 v[32:35], v78
    ds_read_b64_tr_b16 v[24:25], v47 offset:28672
    ds_read_b64_tr_b16 v[26:27], v47 offset:29184
    s_waitcnt lgkmcnt(3)
    v_mfma_f32_32x32x16_bf16 v[112:127], v[28:31], v[36:39], v[112:127]
    ds_read_b128 v[36:39], v79
    ds_read_b64_tr_b16 v[28:29], v47 offset:30720
    ds_read_b64_tr_b16 v[30:31], v47 offset:31232
    s_waitcnt lgkmcnt(3)
    v_mfma_f32_32x32x16_bf16 v[112:127], v[24:27], v[32:35], v[112:127]
    s_waitcnt lgkmcnt(0)
    s_barrier
    ds_read_b128 v[32:35], v48
    ds_read_b64_tr_b16 v[24:25], v44 offset:16384
    ds_read_b64_tr_b16 v[26:27], v44 offset:16896
    v_mfma_f32_32x32x16_bf16 v[112:127], v[28:31], v[36:39], v[112:127]
    ds_read_b128 v[36:39], v49
    ds_read_b64_tr_b16 v[28:29], v44 offset:18432
    ds_read_b64_tr_b16 v[30:31], v44 offset:18944
    s_waitcnt lgkmcnt(3)
    v_mfma_f32_32x32x16_bf16 v[112:127], v[24:27], v[32:35], v[112:127]
    ds_read_b128 v[32:35], v50
    ds_read_b64_tr_b16 v[24:25], v44 offset:20480
    ds_read_b64_tr_b16 v[26:27], v44 offset:20992
    s_waitcnt lgkmcnt(3)
    v_mfma_f32_32x32x16_bf16 v[112:127], v[28:31], v[36:39], v[112:127]
    ds_read_b128 v[36:39], v51
    ds_read_b64_tr_b16 v[28:29], v44 offset:22528
    ds_read_b64_tr_b16 v[30:31], v44 offset:23040
    s_waitcnt lgkmcnt(3)
    v_mfma_f32_32x32x16_bf16 v[112:127], v[24:27], v[32:35], v[112:127]
    ds_read_b128 v[32:35], v52
    ds_read_b64_tr_b16 v[24:25], v44 offset:24576
    ds_read_b64_tr_b16 v[26:27], v44 offset:25088
    s_waitcnt lgkmcnt(3)
    v_mfma_f32_32x32x16_bf16 v[112:127], v[28:31], v[36:39], v[112:127]
    ds_read_b128 v[36:39], v53
    ds_read_b64_tr_b16 v[28:29], v44 offset:26624
    ds_read_b64_tr_b16 v[30:31], v44 offset:27136
    s_waitcnt lgkmcnt(3)
    v_mfma_f32_32x32x16_bf16 v[112:127], v[24:27], v[32:35], v[112:127]
    ds_read_b128 v[32:35], v54
    ds_read_b64_tr_b16 v[24:25], v44 offset:28672
    ds_read_b64_tr_b16 v[26:27], v44 offset:29184
    s_waitcnt lgkmcnt(3)
    v_mfma_f32_32x32x16_bf16 v[112:127], v[28:31], v[36:39], v[112:127]
    ds_read_b128 v[36:39], v55
    ds_read_b64_tr_b16 v[28:29], v44 offset:30720
    ds_read_b64_tr_b16 v[30:31], v44 offset:31232
    s_waitcnt lgkmcnt(3)
    v_mfma_f32_32x32x16_bf16 v[112:127], v[24:27], v[32:35], v[112:127]
    s_waitcnt lgkmcnt(0)
    s_barrier
    ds_read_b128 v[32:35], v56
    ds_read_b64_tr_b16 v[24:25], v45 offset:16384
    ds_read_b64_tr_b16 v[26:27], v45 offset:16896
    v_mfma_f32_32x32x16_bf16 v[112:127], v[28:31], v[36:39], v[112:127]
    ds_read_b128 v[36:39], v57
    ds_read_b64_tr_b16 v[28:29], v45 offset:18432
    ds_read_b64_tr_b16 v[30:31], v45 offset:18944
    s_waitcnt lgkmcnt(3)
    v_mfma_f32_32x32x16_bf16 v[112:127], v[24:27], v[32:35], v[112:127]
    ds_read_b128 v[32:35], v58
    ds_read_b64_tr_b16 v[24:25], v45 offset:20480
    ds_read_b64_tr_b16 v[26:27], v45 offset:20992
    s_waitcnt lgkmcnt(3)
    v_mfma_f32_32x32x16_bf16 v[112:127], v[28:31], v[36:39], v[112:127]
    ds_read_b128 v[36:39], v59
    ds_read_b64_tr_b16 v[28:29], v45 offset:22528
    ds_read_b64_tr_b16 v[30:31], v45 offset:23040
    s_waitcnt lgkmcnt(3)
    v_mfma_f32_32x32x16_bf16 v[112:127], v[24:27], v[32:35], v[112:127]
    ds_read_b128 v[32:35], v60
    ds_read_b64_tr_b16 v[24:25], v45 offset:24576
    ds_read_b64_tr_b16 v[26:27], v45 offset:25088
    s_waitcnt lgkmcnt(3)
    v_mfma_f32_32x32x16_bf16 v[112:127], v[28:31], v[36:39], v[112:127]
    ds_read_b128 v[36:39], v61
    ds_read_b64_tr_b16 v[28:29], v45 offset:26624
    ds_read_b64_tr_b16 v[30:31], v45 offset:27136
    s_waitcnt lgkmcnt(3)
    v_mfma_f32_32x32x16_bf16 v[112:127], v[24:27], v[32:35], v[112:127]
    ds_read_b128 v[32:35], v62
    ds_read_b64_tr_b16 v[24:25], v45 offset:28672
    ds_read_b64_tr_b16 v[26:27], v45 offset:29184
    s_waitcnt lgkmcnt(3)
    v_mfma_f32_32x32x16_bf16 v[112:127], v[28:31], v[36:39], v[112:127]
    ds_read_b128 v[36:39], v63
    ds_read_b64_tr_b16 v[28:29], v45 offset:30720
    ds_read_b64_tr_b16 v[30:31], v45 offset:31232
    s_waitcnt lgkmcnt(3)
    v_mfma_f32_32x32x16_bf16 v[112:127], v[24:27], v[32:35], v[112:127]
    s_waitcnt lgkmcnt(0)
    s_barrier
    ds_read_b128 v[32:35], v64
    ds_read_b64_tr_b16 v[24:25], v46 offset:16384
    ds_read_b64_tr_b16 v[26:27], v46 offset:16896
    v_mfma_f32_32x32x16_bf16 v[112:127], v[28:31], v[36:39], v[112:127]
    ds_read_b128 v[36:39], v65
    ds_read_b64_tr_b16 v[28:29], v46 offset:18432
    ds_read_b64_tr_b16 v[30:31], v46 offset:18944
    s_waitcnt lgkmcnt(3)
    v_mfma_f32_32x32x16_bf16 v[112:127], v[24:27], v[32:35], v[112:127]
    ds_read_b128 v[32:35], v66
    ds_read_b64_tr_b16 v[24:25], v46 offset:20480
    ds_read_b64_tr_b16 v[26:27], v46 offset:20992
    s_waitcnt lgkmcnt(3)
    v_mfma_f32_32x32x16_bf16 v[112:127], v[28:31], v[36:39], v[112:127]
    ds_read_b128 v[36:39], v67
    ds_read_b64_tr_b16 v[28:29], v46 offset:22528
    ds_read_b64_tr_b16 v[30:31], v46 offset:23040
    s_waitcnt lgkmcnt(3)
    v_mfma_f32_32x32x16_bf16 v[112:127], v[24:27], v[32:35], v[112:127]
    ds_read_b128 v[32:35], v68
    ds_read_b64_tr_b16 v[24:25], v46 offset:24576
    ds_read_b64_tr_b16 v[26:27], v46 offset:25088
    s_waitcnt lgkmcnt(3)
    v_mfma_f32_32x32x16_bf16 v[112:127], v[28:31], v[36:39], v[112:127]
    ds_read_b128 v[36:39], v69
    ds_read_b64_tr_b16 v[28:29], v46 offset:26624
    ds_read_b64_tr_b16 v[30:31], v46 offset:27136
    s_waitcnt lgkmcnt(3)
    v_mfma_f32_32x32x16_bf16 v[112:127], v[24:27], v[32:35], v[112:127]
    ds_read_b128 v[32:35], v70
    ds_read_b64_tr_b16 v[24:25], v46 offset:28672
    ds_read_b64_tr_b16 v[26:27], v46 offset:29184
    s_waitcnt lgkmcnt(3)
    v_mfma_f32_32x32x16_bf16 v[112:127], v[28:31], v[36:39], v[112:127]
    ds_read_b128 v[36:39], v71
    ds_read_b64_tr_b16 v[28:29], v46 offset:30720
    ds_read_b64_tr_b16 v[30:31], v46 offset:31232
    s_waitcnt lgkmcnt(3)
    v_mfma_f32_32x32x16_bf16 v[112:127], v[24:27], v[32:35], v[112:127]
    s_waitcnt lgkmcnt(0)
    s_barrier
    ds_read_b128 v[32:35], v72
    ds_read_b64_tr_b16 v[24:25], v47 offset:16384
    ds_read_b64_tr_b16 v[26:27], v47 offset:16896
    v_mfma_f32_32x32x16_bf16 v[112:127], v[28:31], v[36:39], v[112:127]
    ds_read_b128 v[36:39], v73
    ds_read_b64_tr_b16 v[28:29], v47 offset:18432
    ds_read_b64_tr_b16 v[30:31], v47 offset:18944
    s_waitcnt lgkmcnt(3)
    v_mfma_f32_32x32x16_bf16 v[112:127], v[24:27], v[32:35], v[112:127]
    ds_read_b128 v[32:35], v74
    ds_read_b64_tr_b16 v[24:25], v47 offset:20480
    ds_read_b64_tr_b16 v[26:27], v47 offset:20992
    s_waitcnt lgkmcnt(3)
    v_mfma_f32_32x32x16_bf16 v[112:127], v[28:31], v[36:39], v[112:127]
    ds_read_b128 v[36:39], v75
    ds_read_b64_tr_b16 v[28:29], v47 offset:22528
    ds_read_b64_tr_b16 v[30:31], v47 offset:23040
    s_waitcnt lgkmcnt(3)
    v_mfma_f32_32x32x16_bf16 v[112:127], v[24:27], v[32:35], v[112:127]
    ds_read_b128 v[32:35], v76
    ds_read_b64_tr_b16 v[24:25], v47 offset:24576
    ds_read_b64_tr_b16 v[26:27], v47 offset:25088
    s_waitcnt lgkmcnt(3)
    v_mfma_f32_32x32x16_bf16 v[112:127], v[28:31], v[36:39], v[112:127]
    ds_read_b128 v[36:39], v77
    ds_read_b64_tr_b16 v[28:29], v47 offset:26624
    ds_read_b64_tr_b16 v[30:31], v47 offset:27136
    s_waitcnt lgkmcnt(3)
    v_mfma_f32_32x32x16_bf16 v[112:127], v[24:27], v[32:35], v[112:127]
    ds_read_b128 v[32:35], v78
    ds_read_b64_tr_b16 v[24:25], v47 offset:28672
    ds_read_b64_tr_b16 v[26:27], v47 offset:29184
    s_waitcnt lgkmcnt(3)
    v_mfma_f32_32x32x16_bf16 v[112:127], v[28:31], v[36:39], v[112:127]
    ds_read_b128 v[36:39], v79
    ds_read_b64_tr_b16 v[28:29], v47 offset:30720
    ds_read_b64_tr_b16 v[30:31], v47 offset:31232
    s_waitcnt lgkmcnt(3)
    v_mfma_f32_32x32x16_bf16 v[112:127], v[24:27], v[32:35], v[112:127]
    s_waitcnt lgkmcnt(0)
    s_barrier
    ds_read_b128 v[32:35], v48
    ds_read_b64_tr_b16 v[24:25], v44 offset:16384
    ds_read_b64_tr_b16 v[26:27], v44 offset:16896
    v_mfma_f32_32x32x16_bf16 v[112:127], v[28:31], v[36:39], v[112:127]
    ds_read_b128 v[36:39], v49
    ds_read_b64_tr_b16 v[28:29], v44 offset:18432
    ds_read_b64_tr_b16 v[30:31], v44 offset:18944
    s_waitcnt lgkmcnt(3)
    v_mfma_f32_32x32x16_bf16 v[112:127], v[24:27], v[32:35], v[112:127]
    ds_read_b128 v[32:35], v50
    ds_read_b64_tr_b16 v[24:25], v44 offset:20480
    ds_read_b64_tr_b16 v[26:27], v44 offset:20992
    s_waitcnt lgkmcnt(3)
    v_mfma_f32_32x32x16_bf16 v[112:127], v[28:31], v[36:39], v[112:127]
    ds_read_b128 v[36:39], v51
    ds_read_b64_tr_b16 v[28:29], v44 offset:22528
    ds_read_b64_tr_b16 v[30:31], v44 offset:23040
    s_waitcnt lgkmcnt(3)
    v_mfma_f32_32x32x16_bf16 v[112:127], v[24:27], v[32:35], v[112:127]
    ds_read_b128 v[32:35], v52
    ds_read_b64_tr_b16 v[24:25], v44 offset:24576
    ds_read_b64_tr_b16 v[26:27], v44 offset:25088
    s_waitcnt lgkmcnt(3)
    v_mfma_f32_32x32x16_bf16 v[112:127], v[28:31], v[36:39], v[112:127]
    ds_read_b128 v[36:39], v53
    ds_read_b64_tr_b16 v[28:29], v44 offset:26624
    ds_read_b64_tr_b16 v[30:31], v44 offset:27136
    s_waitcnt lgkmcnt(3)
    v_mfma_f32_32x32x16_bf16 v[112:127], v[24:27], v[32:35], v[112:127]
    ds_read_b128 v[32:35], v54
    ds_read_b64_tr_b16 v[24:25], v44 offset:28672
    ds_read_b64_tr_b16 v[26:27], v44 offset:29184
    s_waitcnt lgkmcnt(3)
    v_mfma_f32_32x32x16_bf16 v[112:127], v[28:31], v[36:39], v[112:127]
    ds_read_b128 v[36:39], v55
    ds_read_b64_tr_b16 v[28:29], v44 offset:30720
    ds_read_b64_tr_b16 v[30:31], v44 offset:31232
    s_waitcnt lgkmcnt(3)
    v_mfma_f32_32x32x16_bf16 v[112:127], v[24:27], v[32:35], v[112:127]
    s_waitcnt lgkmcnt(0)
    s_barrier
    ds_read_b128 v[32:35], v56
    ds_read_b64_tr_b16 v[24:25], v45 offset:16384
    ds_read_b64_tr_b16 v[26:27], v45 offset:16896
    v_mfma_f32_32x32x16_bf16 v[112:127], v[28:31], v[36:39], v[112:127]
    ds_read_b128 v[36:39], v57
    ds_read_b64_tr_b16 v[28:29], v45 offset:18432
    ds_read_b64_tr_b16 v[30:31], v45 offset:18944
    s_waitcnt lgkmcnt(3)
    v_mfma_f32_32x32x16_bf16 v[112:127], v[24:27], v[32:35], v[112:127]
    ds_read_b128 v[32:35], v58
    ds_read_b64_tr_b16 v[24:25], v45 offset:20480
    ds_read_b64_tr_b16 v[26:27], v45 offset:20992
    s_waitcnt lgkmcnt(3)
    v_mfma_f32_32x32x16_bf16 v[112:127], v[28:31], v[36:39], v[112:127]
    ds_read_b128 v[36:39], v59
    ds_read_b64_tr_b16 v[28:29], v45 offset:22528
    ds_read_b64_tr_b16 v[30:31], v45 offset:23040
    s_waitcnt lgkmcnt(3)
    v_mfma_f32_32x32x16_bf16 v[112:127], v[24:27], v[32:35], v[112:127]
    ds_read_b128 v[32:35], v60
    ds_read_b64_tr_b16 v[24:25], v45 offset:24576
    ds_read_b64_tr_b16 v[26:27], v45 offset:25088
    s_waitcnt lgkmcnt(3)
    v_mfma_f32_32x32x16_bf16 v[112:127], v[28:31], v[36:39], v[112:127]
    ds_read_b128 v[36:39], v61
    ds_read_b64_tr_b16 v[28:29], v45 offset:26624
    ds_read_b64_tr_b16 v[30:31], v45 offset:27136
    s_waitcnt lgkmcnt(3)
    v_mfma_f32_32x32x16_bf16 v[112:127], v[24:27], v[32:35], v[112:127]
    ds_read_b128 v[32:35], v62
    ds_read_b64_tr_b16 v[24:25], v45 offset:28672
    ds_read_b64_tr_b16 v[26:27], v45 offset:29184
    s_waitcnt lgkmcnt(3)
    v_mfma_f32_32x32x16_bf16 v[112:127], v[28:31], v[36:39], v[112:127]
    ds_read_b128 v[36:39], v63
    ds_read_b64_tr_b16 v[28:29], v45 offset:30720
    ds_read_b64_tr_b16 v[30:31], v45 offset:31232
    s_waitcnt lgkmcnt(3)
    v_mfma_f32_32x32x16_bf16 v[112:127], v[24:27], v[32:35], v[112:127]
    s_waitcnt lgkmcnt(0)
    s_barrier
    ds_read_b128 v[32:35], v64
    ds_read_b64_tr_b16 v[24:25], v46 offset:16384
    ds_read_b64_tr_b16 v[26:27], v46 offset:16896
    v_mfma_f32_32x32x16_bf16 v[112:127], v[28:31], v[36:39], v[112:127]
    ds_read_b128 v[36:39], v65
    ds_read_b64_tr_b16 v[28:29], v46 offset:18432
    ds_read_b64_tr_b16 v[30:31], v46 offset:18944
    s_waitcnt lgkmcnt(3)
    v_mfma_f32_32x32x16_bf16 v[112:127], v[24:27], v[32:35], v[112:127]
    ds_read_b128 v[32:35], v66
    ds_read_b64_tr_b16 v[24:25], v46 offset:20480
    ds_read_b64_tr_b16 v[26:27], v46 offset:20992
    s_waitcnt lgkmcnt(3)
    v_mfma_f32_32x32x16_bf16 v[112:127], v[28:31], v[36:39], v[112:127]
    ds_read_b128 v[36:39], v67
    ds_read_b64_tr_b16 v[28:29], v46 offset:22528
    ds_read_b64_tr_b16 v[30:31], v46 offset:23040
    s_waitcnt lgkmcnt(3)
    v_mfma_f32_32x32x16_bf16 v[112:127], v[24:27], v[32:35], v[112:127]
    ds_read_b128 v[32:35], v68
    ds_read_b64_tr_b16 v[24:25], v46 offset:24576
    ds_read_b64_tr_b16 v[26:27], v46 offset:25088
    s_waitcnt lgkmcnt(3)
    v_mfma_f32_32x32x16_bf16 v[112:127], v[28:31], v[36:39], v[112:127]
    ds_read_b128 v[36:39], v69
    ds_read_b64_tr_b16 v[28:29], v46 offset:26624
    ds_read_b64_tr_b16 v[30:31], v46 offset:27136
    s_waitcnt lgkmcnt(3)
    v_mfma_f32_32x32x16_bf16 v[112:127], v[24:27], v[32:35], v[112:127]
    s_waitcnt lgkmcnt(0)
    v_mfma_f32_32x32x16_bf16 v[112:127], v[28:31], v[36:39], v[112:127]
    s_waitcnt vmcnt(0)
    s_nop 15
    v_cvt_pk_bf16_f32 v80, v112, v113
    v_cvt_pk_bf16_f32 v81, v114, v115
    v_cvt_pk_bf16_f32 v82, v116, v117
    v_cvt_pk_bf16_f32 v83, v118, v119
    v_cvt_pk_bf16_f32 v84, v120, v121
    v_cvt_pk_bf16_f32 v85, v122, v123
    v_cvt_pk_bf16_f32 v86, v124, v125
    v_cvt_pk_bf16_f32 v87, v126, v127
    v_lshlrev_b32 v112, 16, v80
    v_and_b32 v113, 0xffff0000, v80
    v_lshlrev_b32 v88, 16, v16
    v_and_b32 v89, 0xffff0000, v16
    v_lshlrev_b32 v114, 16, v81
    v_and_b32 v115, 0xffff0000, v81
    v_lshlrev_b32 v90, 16, v17
    v_and_b32 v91, 0xffff0000, v17
    v_lshlrev_b32 v116, 16, v82
    v_and_b32 v117, 0xffff0000, v82
    v_lshlrev_b32 v92, 16, v18
    v_and_b32 v93, 0xffff0000, v18
    v_lshlrev_b32 v118, 16, v83
    v_and_b32 v119, 0xffff0000, v83
    v_lshlrev_b32 v94, 16, v19
    v_and_b32 v95, 0xffff0000, v19
    v_lshlrev_b32 v120, 16, v84
    v_and_b32 v121, 0xffff0000, v84
    v_lshlrev_b32 v96, 16, v20
    v_and_b32 v97, 0xffff0000, v20
    v_lshlrev_b32 v122, 16, v85
    v_and_b32 v123, 0xffff0000, v85
    v_lshlrev_b32 v98, 16, v21
    v_and_b32 v99, 0xffff0000, v21
    v_lshlrev_b32 v124, 16, v86
    v_and_b32 v125, 0xffff0000, v86
    v_lshlrev_b32 v100, 16, v22
    v_and_b32 v101, 0xffff0000, v22
    v_lshlrev_b32 v126, 16, v87
    v_and_b32 v127, 0xffff0000, v87
    v_lshlrev_b32 v102, 16, v23
    v_and_b32 v103, 0xffff0000, v23
    v_add_f32 v112, v112, v88
    v_add_f32 v113, v113, v89
    v_add_f32 v114, v114, v90
    v_add_f32 v115, v115, v91
    v_add_f32 v116, v116, v92
    v_add_f32 v117, v117, v93
    v_add_f32 v118, v118, v94
    v_add_f32 v119, v119, v95
    v_add_f32 v120, v120, v96
    v_add_f32 v121, v121, v97
    v_add_f32 v122, v122, v98
    v_add_f32 v123, v123, v99
    v_add_f32 v124, v124, v100
    v_add_f32 v125, v125, v101
    v_add_f32 v126, v126, v102
    v_add_f32 v127, v127, v103
    v_cvt_pk_bf16_f32 v80, v112, v113
    v_cvt_pk_bf16_f32 v81, v114, v115
    v_cvt_pk_bf16_f32 v82, v116, v117
    v_cvt_pk_bf16_f32 v83, v118, v119
    v_cvt_pk_bf16_f32 v84, v120, v121
    v_cvt_pk_bf16_f32 v85, v122, v123
    v_cvt_pk_bf16_f32 v86, v124, v125
    v_cvt_pk_bf16_f32 v87, v126, v127
    v_lshl_add_u32 v7, v3, 3, v7
    s_nop 0
    v_permlane32_swap_b32 v80, v82
    v_permlane32_swap_b32 v81, v83
    v_permlane32_swap_b32 v84, v86
    v_permlane32_swap_b32 v85, v87
    buffer_store_dwordx4 v[80:83], v7, s[12:15], s40 offen offset:0
    buffer_store_dwordx4 v[84:87], v7, s[12:15], s40 offen offset:32
k4_end:
    s_endpgm

.section .rodata,"a"
.p2align 6
.amdhsa_kernel k1_kernel
  .amdhsa_next_free_vgpr 240
  .amdhsa_next_free_sgpr 102
  .amdhsa_accum_offset 240
  .amdhsa_group_segment_fixed_size 0
  .amdhsa_kernarg_size 80
  .amdhsa_user_sgpr_count 2
  .amdhsa_user_sgpr_kernarg_segment_ptr 1
  .amdhsa_system_sgpr_workgroup_id_x 1
  .amdhsa_float_denorm_mode_32 3
.end_amdhsa_kernel

.p2align 6
.amdhsa_kernel k2_kernel
  .amdhsa_next_free_vgpr 256
  .amdhsa_next_free_sgpr 102
  .amdhsa_accum_offset 256
  .amdhsa_group_segment_fixed_size 0
  .amdhsa_kernarg_size 80
  .amdhsa_user_sgpr_count 2
  .amdhsa_user_sgpr_kernarg_segment_ptr 1
  .amdhsa_system_sgpr_workgroup_id_x 1
  .amdhsa_float_denorm_mode_32 3
.end_amdhsa_kernel

.p2align 6
.amdhsa_kernel k3_kernel
  .amdhsa_next_free_vgpr 256
  .amdhsa_next_free_sgpr 102
  .amdhsa_accum_offset 256
  .amdhsa_group_segment_fixed_size 0
  .amdhsa_kernarg_size 80
  .amdhsa_user_sgpr_count 2
  .amdhsa_user_sgpr_kernarg_segment_ptr 1
  .amdhsa_system_sgpr_workgroup_id_x 1
  .amdhsa_float_denorm_mode_32 3
.end_amdhsa_kernel

.p2align 6
.amdhsa_kernel k4_kernel
  .amdhsa_next_free_vgpr 128
  .amdhsa_next_free_sgpr 102
  .amdhsa_accum_offset 128
  .amdhsa_group_segment_fixed_size 0
  .amdhsa_kernarg_size 80
  .amdhsa_user_sgpr_count 2
  .amdhsa_user_sgpr_kernarg_segment_ptr 1
  .amdhsa_system_sgpr_workgroup_id_x 1
  .amdhsa_float_denorm_mode_32 3
.end_amdhsa_kernel
```
